```python
import torch

def _softmax(x, axis=-1):
    return torch.softmax(x, dim=axis)
def _gelu(x):
    return torch.nn.functional.gelu(x, approximate="tanh")
def _silu(x):
    return torch.nn.functional.silu(x)
def _sigmoid(x):
    return torch.sigmoid(x)
def _layernorm(x, axis=-1, eps=1e-5):
    m = x.mean(dim=axis, keepdim=True)
    v = x.var(dim=axis, keepdim=True, unbiased=False)
    return (x - m) / torch.sqrt(v + eps)
def _scatter_add(tgt, idx, src, axis=0):
    return tgt.clone().index_add_(axis, idx, src)
def _segment_sum(src, seg, n):
    out = torch.zeros((n,) + src.shape[1:], dtype=src.dtype)
    return out.index_add_(0, seg, src)
def _pad(x, pw):
    flat = tuple(v for pair in reversed(pw) for v in pair)
    return torch.nn.functional.pad(x, flat)

kernel_name = 'recurrent_scan__spectral_fnet__glu_gated_bilinear__prompt'

def setup_inputs():

    _w = (lambda a: (lambda t: t.to(torch.bfloat16) if t.is_floating_point() else t)(torch.as_tensor(a)))
    def _A_setup():
        B, S, D = 1, 2048, 512
        ns = torch.arange(S)[:, None] * torch.arange(S)[None, :]
        nd = torch.arange(D)[:, None] * torch.arange(D)[None, :]
        Ws_re = torch.cos(-2.0 * torch.pi * ns / S).to(float)
        Ws_im = torch.sin(-2.0 * torch.pi * ns / S).to(float)
        Wd_re = torch.cos(-2.0 * torch.pi * nd / D).to(float)
        Wd_im = torch.sin(-2.0 * torch.pi * nd / D).to(float)
        return {
            "x": _w((lambda *s: torch.randn(*s, dtype=torch.bfloat16) * 0.05)(B, S, D)),
            "dft_seq_re": _w(Ws_re),
            "dft_seq_im": _w(Ws_im),
            "dft_hid_re": _w(Wd_re),
            "dft_hid_im": _w(Wd_im),
        }
    _A_in = _A_setup()

    def _B_setup():
        B, S, D, F = 1, 2048, 512, 1376
        return {
            "x": _w((lambda *s: torch.randn(*s, dtype=torch.bfloat16) * 0.05)(B, S, D)),
            "w_gate": _w((lambda *s: torch.randn(*s, dtype=torch.bfloat16) * 0.05)(D, F) * (D ** -0.5)),
            "w_up": _w((lambda *s: torch.randn(*s, dtype=torch.bfloat16) * 0.05)(D, F) * (D ** -0.5)),
            "w_down": _w((lambda *s: torch.randn(*s, dtype=torch.bfloat16) * 0.05)(F, D) * (F ** -0.5)),
        }
    _B_in = _B_setup()

    return {
        "A_x": _A_in["x"],
        "A_dft_seq_re": _A_in["dft_seq_re"],
        "A_dft_seq_im": _A_in["dft_seq_im"],
        "A_dft_hid_re": _A_in["dft_hid_re"],
        "A_dft_hid_im": _A_in["dft_hid_im"],
        "B_x": _B_in["x"],
        "B_w_gate": _B_in["w_gate"],
        "B_w_up": _B_in["w_up"],
        "B_w_down": _B_in["w_down"],
    }

def reference(A_x, A_dft_seq_re, A_dft_seq_im, A_dft_hid_re, A_dft_hid_im, B_x, B_w_gate, B_w_up, B_w_down):
    def _A_ref(x, dft_seq_re, dft_seq_im, dft_hid_re, dft_hid_im):
        a = torch.einsum("bsd,ed->bse", x, dft_hid_re)
        b = torch.einsum("bsd,ed->bse", x, dft_hid_im)
        y = torch.einsum("ts,bse->bte", dft_seq_re, a) - torch.einsum("ts,bse->bte", dft_seq_im, b)
        return y

    def _B_ref(x, w_gate, w_up, w_down):
        g = torch.einsum("bsd,df->bsf", x, w_gate)
        u = torch.einsum("bsd,df->bsf", x, w_up)
        h = g * u
        return torch.einsum("bsf,fd->bsd", h, w_down)

    x = A_x
    xn = _layernorm(x, axis=-1)
    s = _A_ref(xn, A_dft_seq_re, A_dft_seq_im, A_dft_hid_re, A_dft_hid_im)
    g = _silu(_B_ref(xn, B_w_gate, B_w_up, B_w_down))
    return x + s * g
```

```asm
; @launch grid=(256,1,1) block=(512,1,1) lds=163840
.amdgcn_target "amdgcn-amd-amdhsa--gfx950"
.text
.globl recurrent_scan__spectral_fnet__glu_gated_bilinear__prompt_kernel
.p2align 8
.type recurrent_scan__spectral_fnet__glu_gated_bilinear__prompt_kernel,@function
recurrent_scan__spectral_fnet__glu_gated_bilinear__prompt_kernel:
    s_cmp_ge_u32 s2, 256
    s_cbranch_scc1 L_end
    s_load_dwordx2 s[8:9], s[0:1], 0
    s_load_dwordx4 s[28:31], s[0:1], 48
    s_load_dwordx2 s[16:17], s[0:1], 64
    s_load_dwordx2 s[24:25], s[0:1], 72
    s_load_dwordx2 s[20:21], s[0:1], 88
    s_getpc_b64 s[4:5]
    s_and_b32 s5, s5, 0xffff
    s_mov_b32 s6, L_end - . + 16
    s_mov_b32 s7, 0x20000
    s_lshr_b32 s44, s2, 3
    s_lshl_b32 s44, s44, 10
    v_lshlrev_b32 v16, 7, v0
    v_cmp_gt_u32 vcc, 8, v0
    s_and_saveexec_b64 s[62:63], vcc
    s_cbranch_execz L_nopf
    buffer_load_dword v247, v16, s[4:7], s44 offen
L_nopf:
    s_mov_b64 exec, s[62:63]
    v_lshrrev_b32 v16, 6, v0
    v_and_b32 v0, 63, v0
    v_readfirstlane_b32 s33, v16
    s_and_b32 s44, s2, 7
    s_lshr_b32 s45, s2, 3
    s_and_b32 s36, s44, 1
    s_lshl_b32 s36, s36, 3
    s_and_b32 s46, s45, 7
    s_add_u32 s36, s36, s46
    s_lshr_b32 s37, s44, 1
    s_lshl_b32 s37, s37, 2
    s_lshr_b32 s46, s45, 3
    s_add_u32 s37, s37, s46
    s_and_b32 s34, s33, 3
    s_and_b32 s53, s33, 1
    s_bfe_u32 s54, s33, 0x10001
    s_mul_i32 s39, s37, 171
    s_lshr_b32 s39, s39, 6
    s_lshl_b32 s39, s39, 1
    s_add_u32 s59, s36, s37
    s_and_b32 s59, s59, 0
    s_lshl_b32 s59, s59, 0
    s_cmp_ge_u32 s33, 4
    s_cbranch_scc0 L_compute
    s_mov_b32 s44, s36
    s_sub_u32 s45, 32, s36
    s_cmp_eq_u32 s36, 0
    s_cselect_b32 s45, 16, s45
    s_cmp_ge_u32 s34, 2
    s_cselect_b32 s38, s45, s44
    s_lshl_b32 s46, s53, 5
    s_add_u32 s38, s38, s46
    v_lshrrev_b32 v16, 3, v0
    v_and_b32 v17, 7, v0
    v_lshrrev_b32 v18, 4, v0
    v_xor_b32 v19, v17, v18
    v_lshlrev_b32 v16, 16, v16
    s_lshl_b32 s44, s38, 10
    v_add_u32 v16, s44, v16
    v_lshl_add_u32 v1, v19, 4, v16
    v_xor_b32 v2, 64, v1
    v_add_u32 v2, 523264, v2
    v_add_u32 v3, 1046528, v1
    v_add_u32 v4, 1046528, v2
    s_lshl_b32 s42, s34, 12
    s_waitcnt lgkmcnt(0)
    s_and_b32 s9, s9, 0xffff
    s_mov_b32 s10, 2097152
    s_mov_b32 s11, 0x20000
    s_add_u32 s41, s59, 0
    s_and_b32 s41, s41, 7
    s_add_u32 m0, s42, 0
    s_lshl_b32 s40, s41, 7
    buffer_load_dwordx4 v1, s[8:11], s40 offen lds
    buffer_load_dwordx4 v2, s[8:11], s40 offen offset:1024 lds
    buffer_load_dwordx4 v3, s[8:11], s40 offen offset:2048 lds
    buffer_load_dwordx4 v4, s[8:11], s40 offen offset:3072 lds
    s_mul_i32 s43, s53, 12288
    s_mul_i32 s46, s54, 6144
    s_add_u32 s43, s43, s46
    s_add_u32 s43, s43, 49152
    s_mul_i32 s45, s54, 88064
    s_lshl_b32 s46, s39, 5
    s_add_u32 s45, s45, s46
    s_lshl_b32 s46, s53, 1
    v_add_u32 v16, 0, v0
    v_mul_u32_u24 v17, 171, v16
    v_lshrrev_b32 v17, 11, v17
    v_mul_u32_u24 v18, 12, v17
    v_sub_u32 v18, v16, v18
    v_xor_b32 v18, s46, v18
    v_mul_u32_u24 v17, 2752, v17
    v_lshl_add_u32 v17, v18, 4, v17
    v_add_u32 v5, s45, v17
    v_add_u32 v16, 64, v0
    v_mul_u32_u24 v17, 171, v16
    v_lshrrev_b32 v17, 11, v17
    v_mul_u32_u24 v18, 12, v17
    v_sub_u32 v18, v16, v18
    v_xor_b32 v18, s46, v18
    v_mul_u32_u24 v17, 2752, v17
    v_lshl_add_u32 v17, v18, 4, v17
    v_add_u32 v6, s45, v17
    v_subrev_u32 v6, 1024, v6
    v_add_u32 v16, 128, v0
    v_mul_u32_u24 v17, 171, v16
    v_lshrrev_b32 v17, 11, v17
    v_mul_u32_u24 v18, 12, v17
    v_sub_u32 v18, v16, v18
    v_xor_b32 v18, s46, v18
    v_mul_u32_u24 v17, 2752, v17
    v_lshl_add_u32 v17, v18, 4, v17
    v_add_u32 v7, s45, v17
    v_subrev_u32 v7, 2048, v7
    s_cmp_eq_u32 s53, 0
    s_cselect_b32 s12, s28, s30
    s_cselect_b32 s13, s29, s31
    s_and_b32 s13, s13, 0xffff
    s_mov_b32 s14, 1409024
    s_mov_b32 s15, 0x20000
    s_add_u32 m0, s43, 0
    s_mul_i32 s41, s41, 176128
    buffer_load_dwordx4 v5, s[12:15], s41 offen lds
    buffer_load_dwordx4 v6, s[12:15], s41 offen offset:1024 lds
    s_add_u32 m0, s43, 0
    s_add_u32 s35, s41, 44032
    buffer_load_dwordx4 v7, s[12:15], s41 offen offset:2048 lds
    s_add_u32 m0, s43, 3072
    s_nop 0
    buffer_load_dwordx4 v5, s[12:15], s35 offen lds
    buffer_load_dwordx4 v6, s[12:15], s35 offen offset:1024 lds
    buffer_load_dwordx4 v7, s[12:15], s35 offen offset:2048 lds
    s_add_u32 s62, s20, 8781824
    s_addc_u32 s63, s21, 0
    s_load_dword s49, s[62:63], 0
    s_and_b32 s21, s21, 0xffff
    s_mov_b32 s22, 9175040
    s_mov_b32 s23, 0x20000
    s_and_b32 s17, s17, 0xffff
    s_mov_b32 s18, 1409024
    s_mov_b32 s19, 0x20000
    s_and_b32 s56, s2, 7
    s_lshl_b32 s56, s56, 1
    s_lshr_b32 s44, s2, 7
    s_add_u32 s56, s56, s44
    s_bfe_u32 s55, s2, 0x10006
    s_bfe_u32 s52, s2, 0x30003
    s_mov_b32 s44, s56
    s_sub_u32 s45, 32, s56
    s_cmp_eq_u32 s56, 0
    s_cselect_b32 s45, 16, s45
    s_cmp_eq_u32 s55, 0
    s_cselect_b32 s51, s44, s45
    v_mov_b32 v245, 1
    s_lshl_b32 s44, s34, 2
    s_add_u32 s44, s44, 163328
    v_mov_b32 v246, s44
    v_and_b32 v16, 31, v0
    v_lshrrev_b32 v17, 5, v0
    v_bfe_u32 v18, v0, 1, 3
    v_xor_b32 v18, v18, v17
    v_lshlrev_b32 v12, 4, v16
    v_lshlrev_b32 v16, 7, v16
    v_lshl_add_u32 v16, v18, 4, v16
    v_add_u32 v8, s42, v16
    v_xor_b32 v9, 32, v8
    v_xor_b32 v10, 64, v8
    v_xor_b32 v11, 96, v8
    v_lshrrev_b32 v16, 3, v0
    v_bfe_u32 v17, v0, 4, 1
    v_lshlrev_b32 v17, 2, v17
    v_and_b32 v18, 7, v0
    v_xor_b32 v17, v17, v18
    v_lshlrev_b32 v16, 10, v16
    v_lshl_add_u32 v244, v17, 4, v16
    s_lshl_b32 s57, s54, 11
    s_lshl_b32 s44, s53, 10
    s_add_u32 s57, s57, s44
    s_mul_i32 s58, s54, 704512
    s_lshl_b32 s44, s53, 13
    s_add_u32 s58, s58, s44
    s_lshl_b32 s44, s52, 7
    s_add_u32 s58, s58, s44
    s_mul_i32 s44, s52, 5
    s_sub_u32 s61, 43, s44
    s_lshl_b32 s44, s44, 14
    s_add_u32 s58, s58, s44
    s_sub_u32 s3, s58, 704512
    s_lshl_b32 s48, s36, 2
    s_add_u32 s48, s48, s34
    s_lshl_b32 s48, s48, 9
    s_add_u32 s48, s48, 8847360
    v_lshrrev_b32 v16, 4, v0
    v_and_b32 v17, 15, v0
    v_min_u32 v17, 11, v17
    v_mul_u32_u24 v18, 2752, v16
    v_lshl_add_u32 v13, v17, 4, v18
    s_lshl_b32 s44, s54, 2
    v_add_u32 v16, s44, v16
    v_mul_u32_u24 v16, 384, v16
    v_lshl_add_u32 v16, v17, 5, v16
    s_mul_i32 s44, s53, 3072
    s_add_u32 s44, s44, 155648
    v_add_u32 v14, s44, v16
    s_lshl_b32 s47, s36, 1
    s_add_u32 s47, s47, s54
    s_mul_i32 s47, s47, 44032
    s_lshl_b32 s44, s39, 5
    s_add_u32 s47, s47, s44
    v_and_b32 v18, 31, v0
    v_cvt_f32_u32 v18, v18
    v_mul_f32 v18, 0x3d000000, v18
    v_lshrrev_b32 v19, 5, v0
    v_lshlrev_b32 v19, 2, v19
    v_cvt_f32_u32 v19, v19
    v_mul_f32 v19, v19, v18
    v_fmamk_f32 v20, v18, 0x0, v19
    v_cos_f32 v56, v20
    v_sin_f32 v72, v20
    v_fmamk_f32 v21, v18, 0x3f800000, v19
    v_cos_f32 v57, v21
    v_sin_f32 v73, v21
    v_fmamk_f32 v20, v18, 0x40000000, v19
    v_cos_f32 v58, v20
    v_sin_f32 v74, v20
    v_fmamk_f32 v21, v18, 0x40400000, v19
    v_cos_f32 v59, v21
    v_sin_f32 v75, v21
    v_fmamk_f32 v20, v18, 0x41000000, v19
    v_cos_f32 v60, v20
    v_sin_f32 v76, v20
    v_fmamk_f32 v21, v18, 0x41100000, v19
    v_cos_f32 v61, v21
    v_sin_f32 v77, v21
    v_fmamk_f32 v20, v18, 0x41200000, v19
    v_cos_f32 v62, v20
    v_sin_f32 v78, v20
    v_fmamk_f32 v21, v18, 0x41300000, v19
    v_cos_f32 v63, v21
    v_sin_f32 v79, v21
    v_fmamk_f32 v20, v18, 0x41800000, v19
    v_cos_f32 v64, v20
    v_sin_f32 v80, v20
    v_fmamk_f32 v21, v18, 0x41880000, v19
    v_cos_f32 v65, v21
    v_sin_f32 v81, v21
    v_fmamk_f32 v20, v18, 0x41900000, v19
    v_cos_f32 v66, v20
    v_sin_f32 v82, v20
    v_fmamk_f32 v21, v18, 0x41980000, v19
    v_cos_f32 v67, v21
    v_sin_f32 v83, v21
    v_fmamk_f32 v20, v18, 0x41c00000, v19
    v_cos_f32 v68, v20
    v_sin_f32 v84, v20
    v_fmamk_f32 v21, v18, 0x41c80000, v19
    v_cos_f32 v69, v21
    v_sin_f32 v85, v21
    v_fmamk_f32 v20, v18, 0x41d00000, v19
    v_cos_f32 v70, v20
    v_sin_f32 v86, v20
    v_fmamk_f32 v21, v18, 0x41d80000, v19
    v_cos_f32 v71, v21
    v_sin_f32 v87, v21
    s_add_u32 s41, s59, 1
    s_and_b32 s41, s41, 7
    s_add_u32 m0, s42, 16384
    s_lshl_b32 s40, s41, 7
    buffer_load_dwordx4 v1, s[8:11], s40 offen lds
    buffer_load_dwordx4 v2, s[8:11], s40 offen offset:1024 lds
    buffer_load_dwordx4 v3, s[8:11], s40 offen offset:2048 lds
    buffer_load_dwordx4 v4, s[8:11], s40 offen offset:3072 lds
    s_add_u32 m0, s43, 24576
    s_mul_i32 s41, s41, 176128
    buffer_load_dwordx4 v5, s[12:15], s41 offen lds
    buffer_load_dwordx4 v6, s[12:15], s41 offen offset:1024 lds
    buffer_load_dwordx4 v[40:43], v13, s[12:15], s47 offen
    s_add_u32 s47, s47, 11008
    buffer_load_dwordx4 v[44:47], v13, s[12:15], s47 offen
    s_add_u32 s47, s47, 11008
    buffer_load_dwordx4 v[48:51], v13, s[12:15], s47 offen
    s_add_u32 s47, s47, 11008
    buffer_load_dwordx4 v[52:55], v13, s[12:15], s47 offen
    s_waitcnt vmcnt(10) lgkmcnt(0)
    s_add_u32 s49, s49, 0x9e3779b9
    s_barrier
    s_add_u32 m0, s43, 24576
    s_add_u32 s35, s41, 44032
    buffer_load_dwordx4 v7, s[12:15], s41 offen offset:2048 lds
    ds_read_b128 v[112:115], v8 offset:0
    ds_read_b128 v[116:119], v9 offset:0
    ds_read_b128 v[120:123], v10 offset:0
    ds_read_b128 v[124:127], v11 offset:0
    s_add_u32 m0, s43, 27648
    s_nop 0
    buffer_load_dwordx4 v5, s[12:15], s35 offen lds
    buffer_load_dwordx4 v6, s[12:15], s35 offen offset:1024 lds
    buffer_load_dwordx4 v7, s[12:15], s35 offen offset:2048 lds
    s_add_u32 s41, s59, 2
    s_and_b32 s41, s41, 7
    s_add_u32 m0, s42, 32768
    s_lshl_b32 s40, s41, 7
    buffer_load_dwordx4 v1, s[8:11], s40 offen lds
    buffer_load_dwordx4 v2, s[8:11], s40 offen offset:1024 lds
    buffer_load_dwordx4 v3, s[8:11], s40 offen offset:2048 lds
    buffer_load_dwordx4 v4, s[8:11], s40 offen offset:3072 lds
    s_add_u32 m0, s43, 49152
    s_mul_i32 s41, s41, 176128
    buffer_load_dwordx4 v5, s[12:15], s41 offen lds
    buffer_load_dwordx4 v6, s[12:15], s41 offen offset:1024 lds
    s_waitcnt vmcnt(6) lgkmcnt(0)
    s_barrier
    s_add_u32 m0, s43, 49152
    s_add_u32 s35, s41, 44032
    buffer_load_dwordx4 v7, s[12:15], s41 offen offset:2048 lds
    ds_read_b128 v[128:131], v8 offset:16384
    ds_read_b128 v[132:135], v9 offset:16384
    ds_read_b128 v[136:139], v10 offset:16384
    ds_read_b128 v[140:143], v11 offset:16384
    v_lshlrev_b32 v88, 16, v40
    v_and_b32 v89, 0xffff0000, v40
    v_lshlrev_b32 v90, 16, v41
    v_and_b32 v91, 0xffff0000, v41
    v_lshlrev_b32 v92, 16, v42
    v_and_b32 v93, 0xffff0000, v42
    s_add_u32 m0, s43, 52224
    s_nop 0
    buffer_load_dwordx4 v5, s[12:15], s35 offen lds
    v_lshlrev_b32 v94, 16, v43
    v_and_b32 v95, 0xffff0000, v43
    v_lshlrev_b32 v96, 16, v44
    v_and_b32 v97, 0xffff0000, v44
    v_add_f32 v88, v88, v96
    v_add_f32 v89, v89, v97
    buffer_load_dwordx4 v6, s[12:15], s35 offen offset:1024 lds
    v_lshlrev_b32 v96, 16, v45
    v_and_b32 v97, 0xffff0000, v45
    v_add_f32 v90, v90, v96
    v_add_f32 v91, v91, v97
    v_lshlrev_b32 v96, 16, v46
    v_and_b32 v97, 0xffff0000, v46
    buffer_load_dwordx4 v7, s[12:15], s35 offen offset:2048 lds
    v_add_f32 v92, v92, v96
    v_add_f32 v93, v93, v97
    v_lshlrev_b32 v96, 16, v47
    v_and_b32 v97, 0xffff0000, v47
    v_add_f32 v94, v94, v96
    v_add_f32 v95, v95, v97
    s_add_u32 s41, s59, 3
    s_and_b32 s41, s41, 7
    s_add_u32 m0, s42, 0
    s_lshl_b32 s40, s41, 7
    buffer_load_dwordx4 v1, s[8:11], s40 offen lds
    v_lshlrev_b32 v96, 16, v48
    v_and_b32 v97, 0xffff0000, v48
    v_add_f32 v88, v88, v96
    v_add_f32 v89, v89, v97
    v_lshlrev_b32 v96, 16, v49
    v_and_b32 v97, 0xffff0000, v49
    buffer_load_dwordx4 v2, s[8:11], s40 offen offset:1024 lds
    v_add_f32 v90, v90, v96
    v_add_f32 v91, v91, v97
    v_lshlrev_b32 v96, 16, v50
    v_and_b32 v97, 0xffff0000, v50
    v_add_f32 v92, v92, v96
    v_add_f32 v93, v93, v97
    buffer_load_dwordx4 v3, s[8:11], s40 offen offset:2048 lds
    v_lshlrev_b32 v96, 16, v51
    v_and_b32 v97, 0xffff0000, v51
    v_add_f32 v94, v94, v96
    v_add_f32 v95, v95, v97
    v_lshlrev_b32 v96, 16, v52
    v_and_b32 v97, 0xffff0000, v52
    buffer_load_dwordx4 v4, s[8:11], s40 offen offset:3072 lds
    v_add_f32 v88, v88, v96
    v_add_f32 v89, v89, v97
    v_lshlrev_b32 v96, 16, v53
    v_and_b32 v97, 0xffff0000, v53
    v_add_f32 v90, v90, v96
    v_add_f32 v91, v91, v97
    s_add_u32 m0, s43, 0
    s_mul_i32 s41, s41, 176128
    buffer_load_dwordx4 v5, s[12:15], s41 offen lds
    v_lshlrev_b32 v96, 16, v54
    v_and_b32 v97, 0xffff0000, v54
    v_add_f32 v92, v92, v96
    v_add_f32 v93, v93, v97
    v_lshlrev_b32 v96, 16, v55
    v_and_b32 v97, 0xffff0000, v55
    buffer_load_dwordx4 v6, s[12:15], s41 offen offset:1024 lds
    v_add_f32 v94, v94, v96
    v_add_f32 v95, v95, v97
    ds_write_b128 v14, v[88:91]
    ds_write_b128 v14, v[92:95] offset:16
    s_waitcnt vmcnt(6) lgkmcnt(0)
    s_barrier
    s_add_u32 m0, s43, 0
    s_add_u32 s35, s41, 44032
    buffer_load_dwordx4 v7, s[12:15], s41 offen offset:2048 lds
    ds_read_b128 v[144:147], v8 offset:32768
    ds_read_b128 v[148:151], v9 offset:32768
    ds_read_b128 v[152:155], v10 offset:32768
    ds_read_b128 v[156:159], v11 offset:32768
    v_bfe_u32 v16, v0, 4, 1
    v_mul_u32_u24 v16, 3072, v16
    v_bfe_u32 v17, v0, 2, 1
    v_lshl_add_u32 v16, v17, 5, v16
    v_bfe_u32 v17, v0, 3, 1
    v_lshl_add_u32 v16, v17, 4, v16
    v_and_b32 v17, 3, v0
    s_add_u32 m0, s43, 3072
    s_nop 0
    buffer_load_dwordx4 v5, s[12:15], s35 offen lds
    v_lshl_add_u32 v16, v17, 2, v16
    v_add_u32 v16, 155648, v16
    v_lshrrev_b32 v17, 5, v0
    v_lshl_add_u32 v18, v17, 7, v16
    v_mul_u32_u24 v17, 320, v17
    v_add_u32 v17, v17, v16
    ds_read_b32 v40, v18 offset:64
    buffer_load_dwordx4 v6, s[12:15], s35 offen offset:1024 lds
    ds_read_b32 v41, v18 offset:448
    ds_read_b32 v42, v18 offset:832
    ds_read_b32 v43, v18 offset:1216
    ds_read_b32 v44, v18 offset:1600
    ds_read_b32 v45, v18 offset:1984
    ds_read_b32 v46, v18 offset:2368
    ds_read_b32 v47, v18 offset:2752
    buffer_load_dwordx4 v7, s[12:15], s35 offen offset:2048 lds
    s_waitcnt lgkmcnt(4)
    ds_read_b32 v48, v18 offset:128
    ds_read_b32 v49, v18 offset:512
    ds_read_b32 v50, v18 offset:896
    ds_read_b32 v51, v18 offset:1280
    ds_read_b32 v52, v18 offset:1664
    ds_read_b32 v53, v18 offset:2048
    s_add_u32 s41, s59, 4
    s_and_b32 s41, s41, 7
    s_add_u32 m0, s42, 16384
    s_lshl_b32 s40, s41, 7
    buffer_load_dwordx4 v1, s[8:11], s40 offen lds
    ds_read_b32 v54, v18 offset:2432
    ds_read_b32 v55, v18 offset:2816
    s_waitcnt lgkmcnt(4)
    ds_read_b32 v92, v17 offset:0
    ds_read_b32 v93, v17 offset:384
    ds_read_b32 v94, v17 offset:768
    ds_read_b32 v95, v17 offset:1152
    buffer_load_dwordx4 v2, s[8:11], s40 offen offset:1024 lds
    ds_read_b32 v96, v17 offset:1536
    ds_read_b32 v97, v17 offset:1920
    ds_read_b32 v98, v17 offset:2304
    ds_read_b32 v99, v17 offset:2688
    s_waitcnt lgkmcnt(4)
    s_waitcnt lgkmcnt(0)
    v_add_f32 v40, v40, v44
    buffer_load_dwordx4 v3, s[8:11], s40 offen offset:2048 lds
    v_add_f32 v41, v41, v45
    v_add_f32 v42, v42, v46
    v_add_f32 v43, v43, v47
    v_add_f32 v40, v40, v42
    v_add_f32 v41, v41, v43
    v_add_f32 v88, v40, v41
    v_add_f32 v48, v48, v52
    buffer_load_dwordx4 v4, s[8:11], s40 offen offset:3072 lds
    v_add_f32 v49, v49, v53
    v_add_f32 v50, v50, v54
    v_add_f32 v51, v51, v55
    v_add_f32 v48, v48, v50
    v_add_f32 v49, v49, v51
    v_add_f32 v89, v48, v49
    v_add_f32 v92, v92, v96
    s_add_u32 m0, s43, 24576
    s_mul_i32 s41, s41, 176128
    buffer_load_dwordx4 v5, s[12:15], s41 offen lds
    v_add_f32 v93, v93, v97
    v_add_f32 v94, v94, v98
    v_add_f32 v95, v95, v99
    v_add_f32 v92, v92, v94
    v_add_f32 v93, v93, v95
    v_add_f32 v90, v92, v93
    v_mov_b32 v91, s49
    buffer_load_dwordx4 v6, s[12:15], s41 offen offset:1024 lds
    v_lshlrev_b32 v13, 4, v0
    s_lshl_b32 s47, s37, 14
    s_add_u32 s47, s47, 8912896
    s_lshl_b32 s44, s36, 10
    s_add_u32 s44, s44, s47
    s_lshl_b32 s45, s34, 4
    s_lshl_b64 exec, 0xffff, s45
    buffer_store_dwordx4 v[88:91], v13, s[20:23], s44 offen sc1
    s_mov_b64 exec, -1
    s_lshl_b32 s44, s34, 12
    s_add_u32 s47, s47, s44
    s_waitcnt vmcnt(7) lgkmcnt(0)
    s_barrier
    s_add_u32 m0, s43, 24576
    s_add_u32 s35, s41, 44032
    buffer_load_dwordx4 v7, s[12:15], s41 offen offset:2048 lds
    ds_read_b128 v[160:163], v8 offset:0
    ds_read_b128 v[164:167], v9 offset:0
    ds_read_b128 v[168:171], v10 offset:0
    ds_read_b128 v[172:175], v11 offset:0
    s_add_u32 m0, s43, 27648
    s_nop 0
    buffer_load_dwordx4 v5, s[12:15], s35 offen lds
    buffer_load_dwordx4 v6, s[12:15], s35 offen offset:1024 lds
    buffer_load_dwordx4 v7, s[12:15], s35 offen offset:2048 lds
    s_add_u32 s41, s59, 5
    s_and_b32 s41, s41, 7
    s_add_u32 m0, s42, 32768
    s_lshl_b32 s40, s41, 7
    buffer_load_dwordx4 v1, s[8:11], s40 offen lds
    buffer_load_dwordx4 v2, s[8:11], s40 offen offset:1024 lds
    buffer_load_dwordx4 v3, s[8:11], s40 offen offset:2048 lds
    buffer_load_dwordx4 v4, s[8:11], s40 offen offset:3072 lds
    s_add_u32 m0, s43, 49152
    s_mul_i32 s41, s41, 176128
    buffer_load_dwordx4 v5, s[12:15], s41 offen lds
    buffer_load_dwordx4 v6, s[12:15], s41 offen offset:1024 lds
    s_waitcnt vmcnt(6) lgkmcnt(0)
    s_barrier
    s_add_u32 m0, s43, 49152
    s_add_u32 s35, s41, 44032
    buffer_load_dwordx4 v7, s[12:15], s41 offen offset:2048 lds
    ds_read_b128 v[176:179], v8 offset:16384
    ds_read_b128 v[180:183], v9 offset:16384
    ds_read_b128 v[184:187], v10 offset:16384
    ds_read_b128 v[188:191], v11 offset:16384
    s_mul_i32 s44, s34, 11
    s_add_u32 m0, s43, 52224
    s_nop 0
    buffer_load_dwordx4 v5, s[12:15], s35 offen lds
    v_add_u32 v16, s44, v0
    buffer_load_dwordx4 v6, s[12:15], s35 offen offset:1024 lds
    v_min_u32 v16, 42, v16
    buffer_load_dwordx4 v7, s[12:15], s35 offen offset:2048 lds
    s_add_u32 s44, s44, 10
    s_add_u32 s41, s59, 6
    s_and_b32 s41, s41, 7
    s_add_u32 m0, s42, 0
    s_lshl_b32 s40, s41, 7
    buffer_load_dwordx4 v1, s[8:11], s40 offen lds
    v_min_u32 v16, s44, v16
    buffer_load_dwordx4 v2, s[8:11], s40 offen offset:1024 lds
    v_lshlrev_b32 v16, 10, v16
    buffer_load_dwordx4 v3, s[8:11], s40 offen offset:2048 lds
    s_lshr_b32 s44, s2, 3
    buffer_load_dwordx4 v4, s[8:11], s40 offen offset:3072 lds
    s_mul_i32 s44, s44, 44032
    s_add_u32 m0, s43, 0
    s_mul_i32 s41, s41, 176128
    buffer_load_dwordx4 v5, s[12:15], s41 offen lds
    buffer_load_dwordx4 v6, s[12:15], s41 offen offset:1024 lds
    buffer_load_dwordx4 v[240:243], v12, s[20:23], s48 offen sc1
    buffer_load_dwordx4 v[40:43], v13, s[20:23], s47 offen sc1
    buffer_load_dwordx4 v[44:47], v13, s[20:23], s47 offen offset:1024 sc1
    buffer_load_dwordx4 v[48:51], v13, s[20:23], s47 offen offset:2048 sc1
    buffer_load_dwordx4 v[52:55], v13, s[20:23], s47 offen offset:3072 sc1
    buffer_load_dword v247, v16, s[16:19], s44 offen offset:384
    s_waitcnt vmcnt(12) lgkmcnt(0)
    s_barrier
    s_add_u32 m0, s43, 0
    s_add_u32 s35, s41, 44032
    buffer_load_dwordx4 v7, s[12:15], s41 offen offset:2048 lds
    ds_read_b128 v[192:195], v8 offset:32768
    ds_read_b128 v[196:199], v9 offset:32768
    ds_read_b128 v[200:203], v10 offset:32768
    ds_read_b128 v[204:207], v11 offset:32768
    s_add_u32 m0, s43, 3072
    s_nop 0
    buffer_load_dwordx4 v5, s[12:15], s35 offen lds
    buffer_load_dwordx4 v6, s[12:15], s35 offen offset:1024 lds
    buffer_load_dwordx4 v7, s[12:15], s35 offen offset:2048 lds
    s_add_u32 s41, s59, 7
    s_and_b32 s41, s41, 7
    s_add_u32 m0, s42, 16384
    s_lshl_b32 s40, s41, 7
    buffer_load_dwordx4 v1, s[8:11], s40 offen lds
    buffer_load_dwordx4 v2, s[8:11], s40 offen offset:1024 lds
    buffer_load_dwordx4 v3, s[8:11], s40 offen offset:2048 lds
    buffer_load_dwordx4 v4, s[8:11], s40 offen offset:3072 lds
    s_add_u32 m0, s43, 24576
    s_mul_i32 s41, s41, 176128
    buffer_load_dwordx4 v5, s[12:15], s41 offen lds
    buffer_load_dwordx4 v6, s[12:15], s41 offen offset:1024 lds
    s_waitcnt vmcnt(10)
    s_mov_b32 s50, 1048576
L_hstat:
    v_cmp_ne_u32 s[62:63], s49, v243
    s_cmp_lg_u64 s[62:63], 0
    s_cbranch_scc1 L_hstat_again
    s_branch L_hstat_out
L_hstat_again:
    buffer_load_dwordx4 v[240:243], v12, s[20:23], s48 offen sc1
    s_sub_u32 s50, s50, 1
    s_waitcnt vmcnt(0)
    s_cbranch_scc0 L_hstat
L_hstat_out:
    v_and_b32 v16, 31, v0
    s_lshl_b32 s60, s34, 7
    s_add_u32 s60, s60, 161792
    v_lshl_add_u32 v16, v16, 2, s60
    ds_write_b32 v16, v242
    v_lshrrev_b32 v18, 5, v0
    v_lshl_add_u32 v18, v18, 4, s60
    ds_read_b128 v[88:91], v18 offset:0
    ds_read_b128 v[92:95], v18 offset:32
    ds_read_b128 v[96:99], v18 offset:64
    ds_read_b128 v[100:103], v18 offset:96
    s_mov_b32 s50, 1048576
L_hcol:
    v_cmp_ne_u32 s[62:63], s49, v43
    s_cmp_lg_u64 s[62:63], 0
    s_cbranch_scc1 L_hcol_again
    v_cmp_ne_u32 s[62:63], s49, v47
    s_cmp_lg_u64 s[62:63], 0
    s_cbranch_scc1 L_hcol_again
    v_cmp_ne_u32 s[62:63], s49, v51
    s_cmp_lg_u64 s[62:63], 0
    s_cbranch_scc1 L_hcol_again
    v_cmp_ne_u32 s[62:63], s49, v55
    s_cmp_lg_u64 s[62:63], 0
    s_cbranch_scc1 L_hcol_again
    s_branch L_hcol_out
L_hcol_again:
    buffer_load_dwordx4 v[40:43], v13, s[20:23], s47 offen sc1
    buffer_load_dwordx4 v[44:47], v13, s[20:23], s47 offen offset:1024 sc1
    buffer_load_dwordx4 v[48:51], v13, s[20:23], s47 offen offset:2048 sc1
    buffer_load_dwordx4 v[52:55], v13, s[20:23], s47 offen offset:3072 sc1
    s_sub_u32 s50, s50, 1
    s_waitcnt vmcnt(0)
    s_cbranch_scc0 L_hcol
L_hcol_out:
    v_add_f32 v40, v40, v44
    v_add_f32 v48, v48, v52
    v_add_f32 v41, v41, v45
    v_add_f32 v49, v49, v53
    v_add_f32 v42, v42, v46
    v_add_f32 v50, v50, v54
    s_lshl_b32 s44, s34, 10
    s_add_u32 s44, s44, 155648
    v_add_u32 v14, s44, v13
    v_add_f32 v40, v40, v48
    v_add_f32 v41, v41, v49
    v_add_f32 v42, v42, v50
    ds_write_b128 v14, v[40:43]
    s_waitcnt vmcnt(6) lgkmcnt(0)
    s_barrier
    s_add_u32 m0, s43, 24576
    s_add_u32 s35, s41, 44032
    buffer_load_dwordx4 v7, s[12:15], s41 offen offset:2048 lds
    ds_read_b128 v[208:211], v8 offset:0
    ds_read_b128 v[212:215], v9 offset:0
    ds_read_b128 v[216:219], v10 offset:0
    ds_read_b128 v[220:223], v11 offset:0
    v_mul_f32 v56, v56, v88
    v_mul_f32 v57, v57, v89
    v_mul_f32 v58, v58, v90
    v_mul_f32 v59, v59, v91
    s_add_u32 m0, s43, 27648
    s_nop 0
    buffer_load_dwordx4 v5, s[12:15], s35 offen lds
    v_mul_f32 v60, v60, v92
    v_mul_f32 v61, v61, v93
    v_mul_f32 v62, v62, v94
    v_mul_f32 v63, v63, v95
    buffer_load_dwordx4 v6, s[12:15], s35 offen offset:1024 lds
    v_mul_f32 v64, v64, v96
    v_mul_f32 v65, v65, v97
    v_mul_f32 v66, v66, v98
    v_mul_f32 v67, v67, v99
    buffer_load_dwordx4 v7, s[12:15], s35 offen offset:2048 lds
    v_mul_f32 v68, v68, v100
    v_mul_f32 v69, v69, v101
    v_mul_f32 v70, v70, v102
    v_mul_f32 v71, v71, v103
    s_cmp_gt_u32 s61, 0
    s_cselect_b32 s40, s58, s3
    s_add_u32 m0, s57, 32768
    s_add_u32 s40, s40, 0
    buffer_load_dwordx4 v244, s[16:19], s40 offen lds
    v_mul_f32 v72, v72, v88
    v_mul_f32 v73, v73, v89
    v_mul_f32 v74, v74, v90
    v_mul_f32 v75, v75, v91
    s_cmp_gt_u32 s61, 1
    s_cselect_b32 s40, s58, s3
    s_add_u32 m0, s57, 36864
    s_add_u32 s40, s40, 16384
    buffer_load_dwordx4 v244, s[16:19], s40 offen lds
    v_mul_f32 v76, v76, v92
    v_mul_f32 v77, v77, v93
    v_mul_f32 v78, v78, v94
    v_mul_f32 v79, v79, v95
    s_cmp_gt_u32 s61, 2
    s_cselect_b32 s40, s58, s3
    s_add_u32 m0, s57, 40960
    s_add_u32 s40, s40, 32768
    buffer_load_dwordx4 v244, s[16:19], s40 offen lds
    v_mul_f32 v80, v80, v96
    v_mul_f32 v81, v81, v97
    v_mul_f32 v82, v82, v98
    v_mul_f32 v83, v83, v99
    s_cmp_gt_u32 s61, 3
    s_cselect_b32 s40, s58, s3
    s_add_u32 m0, s57, 45056
    s_add_u32 s40, s40, 49152
    buffer_load_dwordx4 v244, s[16:19], s40 offen lds
    v_mul_f32 v84, v84, v100
    v_mul_f32 v85, v85, v101
    v_mul_f32 v86, v86, v102
    v_mul_f32 v87, v87, v103
    s_cmp_gt_u32 s61, 4
    s_cselect_b32 s40, s58, s3
    s_add_u32 m0, s57, 98304
    s_add_u32 s40, s40, 65536
    buffer_load_dwordx4 v244, s[16:19], s40 offen lds
    v_cvt_pk_bf16_f32 v24, v56, v57
    v_cvt_pk_bf16_f32 v25, v58, v59
    v_cvt_pk_bf16_f32 v26, v60, v61
    v_cvt_pk_bf16_f32 v27, v62, v63
    s_cmp_gt_u32 s61, 5
    s_cselect_b32 s40, s58, s3
    s_add_u32 m0, s57, 102400
    s_add_u32 s40, s40, 81920
    buffer_load_dwordx4 v244, s[16:19], s40 offen lds
    v_cvt_pk_bf16_f32 v28, v64, v65
    v_cvt_pk_bf16_f32 v29, v66, v67
    v_cvt_pk_bf16_f32 v30, v68, v69
    v_cvt_pk_bf16_f32 v31, v70, v71
    s_cmp_gt_u32 s61, 6
    s_cselect_b32 s40, s58, s3
    s_add_u32 m0, s57, 106496
    s_add_u32 s40, s40, 98304
    buffer_load_dwordx4 v244, s[16:19], s40 offen lds
    v_cvt_pk_bf16_f32 v32, v72, v73
    v_cvt_pk_bf16_f32 v33, v74, v75
    v_cvt_pk_bf16_f32 v34, v76, v77
    v_cvt_pk_bf16_f32 v35, v78, v79
    s_cmp_gt_u32 s61, 7
    s_cselect_b32 s40, s58, s3
    s_add_u32 m0, s57, 110592
    s_add_u32 s40, s40, 114688
    buffer_load_dwordx4 v244, s[16:19], s40 offen lds
    v_cvt_pk_bf16_f32 v36, v80, v81
    v_cvt_pk_bf16_f32 v37, v82, v83
    v_cvt_pk_bf16_f32 v38, v84, v85
    v_cvt_pk_bf16_f32 v39, v86, v87
    s_waitcnt vmcnt(8) lgkmcnt(0)
    s_barrier
    ds_read_b128 v[224:227], v8 offset:16384
    ds_read_b128 v[228:231], v9 offset:16384
    ds_read_b128 v[232:235], v10 offset:16384
    ds_read_b128 v[236:239], v11 offset:16384
    s_cmp_gt_u32 s61, 8
    s_cselect_b32 s40, s58, s3
    s_add_u32 m0, s57, 114688
    s_add_u32 s40, s40, 131072
    buffer_load_dwordx4 v244, s[16:19], s40 offen lds
    s_cmp_gt_u32 s61, 9
    s_cselect_b32 s40, s58, s3
    s_add_u32 m0, s57, 118784
    s_add_u32 s40, s40, 147456
    buffer_load_dwordx4 v244, s[16:19], s40 offen lds
    s_waitcnt lgkmcnt(0)
    ds_write_b32 v246, v245 offset:16
    s_cmp_gt_u32 s61, 10
    s_cselect_b32 s40, s58, s3
    s_add_u32 m0, s57, 0
    s_add_u32 s40, s40, 163840
    buffer_load_dwordx4 v244, s[16:19], s40 offen lds
    s_cmp_gt_u32 s61, 11
    s_cselect_b32 s40, s58, s3
    s_add_u32 m0, s57, 4096
    s_add_u32 s40, s40, 180224
    buffer_load_dwordx4 v244, s[16:19], s40 offen lds
    s_cmp_gt_u32 s61, 12
    s_cselect_b32 s40, s58, s3
    s_add_u32 m0, s57, 8192
    s_add_u32 s40, s40, 196608
    buffer_load_dwordx4 v244, s[16:19], s40 offen lds
    s_cmp_gt_u32 s61, 13
    s_cselect_b32 s40, s58, s3
    s_add_u32 m0, s57, 12288
    s_add_u32 s40, s40, 212992
    buffer_load_dwordx4 v244, s[16:19], s40 offen lds
    s_cmp_gt_u32 s61, 14
    s_cselect_b32 s40, s58, s3
    s_add_u32 m0, s57, 49152
    s_add_u32 s40, s40, 229376
    buffer_load_dwordx4 v244, s[16:19], s40 offen lds
    s_cmp_gt_u32 s61, 15
    s_cselect_b32 s40, s58, s3
    s_add_u32 m0, s57, 53248
    s_add_u32 s40, s40, 245760
    buffer_load_dwordx4 v244, s[16:19], s40 offen lds
    s_cmp_gt_u32 s61, 16
    s_cselect_b32 s40, s58, s3
    s_add_u32 m0, s57, 57344
    s_add_u32 s40, s40, 262144
    buffer_load_dwordx4 v244, s[16:19], s40 offen lds
    s_cmp_gt_u32 s61, 17
    s_cselect_b32 s40, s58, s3
    s_add_u32 m0, s57, 61440
    s_add_u32 s40, s40, 278528
    buffer_load_dwordx4 v244, s[16:19], s40 offen lds
    s_cmp_gt_u32 s61, 18
    s_cselect_b32 s40, s58, s3
    s_add_u32 m0, s57, 65536
    s_add_u32 s40, s40, 294912
    buffer_load_dwordx4 v244, s[16:19], s40 offen lds
    s_cmp_gt_u32 s61, 19
    s_cselect_b32 s40, s58, s3
    s_add_u32 m0, s57, 69632
    s_add_u32 s40, s40, 311296
    buffer_load_dwordx4 v244, s[16:19], s40 offen lds
    v_lshlrev_b32 v17, 4, v0
    v_add_u32 v17, 122880, v17
    v_mov_b32 v48, 163328
    s_mov_b32 s50, 1048576
    s_branch L_s7_first
L_s7:
    s_sleep 1
L_s7_first:
    ds_read_b128 v[40:43], v48
    ds_read_b128 v[44:47], v48 offset:16
    s_sub_u32 s50, s50, 1
    s_cbranch_scc1 L_s7_out
    s_waitcnt lgkmcnt(0)
    v_and_b32 v40, v40, v41
    v_and_b32 v42, v42, v43
    v_and_b32 v44, v44, v45
    v_and_b32 v46, v46, v47
    v_and_b32 v40, v40, v44
    v_and_b32 v42, v42, v46
    v_and_b32 v40, v40, v42
    v_cmp_eq_u32 s[62:63], 0, v40
    s_cmp_lg_u64 s[62:63], 0
    s_cbranch_scc1 L_s7
L_s7_out:
    s_waitcnt lgkmcnt(0)
    ds_read_b128 v[88:91], v17 offset:0
    ds_read_b128 v[92:95], v17 offset:1024
    ds_read_b128 v[96:99], v17 offset:2048
    ds_read_b128 v[100:103], v17 offset:3072
    s_waitcnt lgkmcnt(3)
    v_mfma_f32_32x32x16_bf16 v[40:55], v[112:115], v[88:91], 0
    ds_read_b128 v[88:91], v17 offset:4096
    s_waitcnt lgkmcnt(3)
    v_mfma_f32_32x32x16_bf16 v[40:55], v[116:119], v[92:95], v[40:55]
    ds_read_b128 v[92:95], v17 offset:5120
    s_waitcnt lgkmcnt(3)
    v_mfma_f32_32x32x16_bf16 v[40:55], v[120:123], v[96:99], v[40:55]
    s_waitcnt vmcnt(0) lgkmcnt(0)
    ds_write_b32 v246, v245 offset:32
    s_waitcnt lgkmcnt(0)
    ds_read_b128 v[96:99], v17 offset:6144
    s_waitcnt lgkmcnt(3)
    v_mfma_f32_32x32x16_bf16 v[40:55], v[124:127], v[100:103], v[40:55]
    ds_read_b128 v[100:103], v17 offset:7168
    s_waitcnt lgkmcnt(3)
    v_mfma_f32_32x32x16_bf16 v[40:55], v[128:131], v[88:91], v[40:55]
    ds_read_b128 v[88:91], v17 offset:8192
    s_waitcnt lgkmcnt(3)
    v_mfma_f32_32x32x16_bf16 v[40:55], v[132:135], v[92:95], v[40:55]
    ds_read_b128 v[92:95], v17 offset:9216
    s_waitcnt lgkmcnt(3)
    v_mfma_f32_32x32x16_bf16 v[40:55], v[136:139], v[96:99], v[40:55]
    ds_read_b128 v[96:99], v17 offset:10240
    s_waitcnt lgkmcnt(3)
    v_mfma_f32_32x32x16_bf16 v[40:55], v[140:143], v[100:103], v[40:55]
    ds_read_b128 v[100:103], v17 offset:11264
    s_waitcnt lgkmcnt(3)
    v_mfma_f32_32x32x16_bf16 v[40:55], v[144:147], v[88:91], v[40:55]
    ds_read_b128 v[88:91], v17 offset:12288
    s_waitcnt lgkmcnt(3)
    v_mfma_f32_32x32x16_bf16 v[40:55], v[148:151], v[92:95], v[40:55]
    ds_read_b128 v[92:95], v17 offset:13312
    s_waitcnt lgkmcnt(3)
    v_mfma_f32_32x32x16_bf16 v[40:55], v[152:155], v[96:99], v[40:55]
    ds_read_b128 v[96:99], v17 offset:14336
    s_waitcnt lgkmcnt(3)
    v_mfma_f32_32x32x16_bf16 v[40:55], v[156:159], v[100:103], v[40:55]
    ds_read_b128 v[100:103], v17 offset:15360
    s_waitcnt lgkmcnt(3)
    v_mfma_f32_32x32x16_bf16 v[40:55], v[160:163], v[88:91], v[40:55]
    ds_read_b128 v[88:91], v17 offset:16384
    s_waitcnt lgkmcnt(3)
    v_mfma_f32_32x32x16_bf16 v[40:55], v[164:167], v[92:95], v[40:55]
    ds_read_b128 v[92:95], v17 offset:17408
    s_waitcnt lgkmcnt(3)
    v_mfma_f32_32x32x16_bf16 v[40:55], v[168:171], v[96:99], v[40:55]
    ds_read_b128 v[96:99], v17 offset:18432
    s_waitcnt lgkmcnt(3)
    v_mfma_f32_32x32x16_bf16 v[40:55], v[172:175], v[100:103], v[40:55]
    ds_read_b128 v[100:103], v17 offset:19456
    s_waitcnt lgkmcnt(3)
    v_mfma_f32_32x32x16_bf16 v[40:55], v[176:179], v[88:91], v[40:55]
    ds_read_b128 v[88:91], v17 offset:20480
    s_waitcnt lgkmcnt(3)
    v_mfma_f32_32x32x16_bf16 v[40:55], v[180:183], v[92:95], v[40:55]
    ds_read_b128 v[92:95], v17 offset:21504
    s_waitcnt lgkmcnt(3)
    v_mfma_f32_32x32x16_bf16 v[40:55], v[184:187], v[96:99], v[40:55]
    ds_read_b128 v[96:99], v17 offset:22528
    s_waitcnt lgkmcnt(3)
    v_mfma_f32_32x32x16_bf16 v[40:55], v[188:191], v[100:103], v[40:55]
    ds_read_b128 v[100:103], v17 offset:23552
    s_waitcnt lgkmcnt(3)
    v_mfma_f32_32x32x16_bf16 v[40:55], v[192:195], v[88:91], v[40:55]
    ds_read_b128 v[88:91], v17 offset:24576
    s_waitcnt lgkmcnt(3)
    v_mfma_f32_32x32x16_bf16 v[40:55], v[196:199], v[92:95], v[40:55]
    ds_read_b128 v[92:95], v17 offset:25600
    s_waitcnt lgkmcnt(3)
    v_mfma_f32_32x32x16_bf16 v[40:55], v[200:203], v[96:99], v[40:55]
    v_mov_b32 v64, 163488
    s_mov_b32 s50, 1048576
L_st:
    ds_read_b128 v[56:59], v64
    s_sub_u32 s50, s50, 1
    s_cbranch_scc1 L_st_out
    s_waitcnt lgkmcnt(0)
    v_and_b32 v56, v56, v57
    v_and_b32 v58, v58, v59
    v_and_b32 v56, v56, v58
    v_cmp_eq_u32 s[62:63], 0, v56
    s_cmp_lg_u64 s[62:63], 0
    s_cbranch_scc1 L_st
L_st_out:
    s_waitcnt lgkmcnt(0)
    s_cmp_gt_u32 s61, 20
    s_cselect_b32 s40, s58, s3
    s_add_u32 m0, s57, 24576
    s_add_u32 s40, s40, 327680
    buffer_load_dwordx4 v244, s[16:19], s40 offen lds
    ds_read_b128 v[96:99], v17 offset:26624
    s_waitcnt lgkmcnt(3)
    v_mfma_f32_32x32x16_bf16 v[40:55], v[204:207], v[100:103], v[40:55]
    s_cmp_gt_u32 s61, 21
    s_cselect_b32 s40, s58, s3
    s_add_u32 m0, s57, 28672
    s_add_u32 s40, s40, 344064
    buffer_load_dwordx4 v244, s[16:19], s40 offen lds
    ds_read_b128 v[100:103], v17 offset:27648
    s_waitcnt lgkmcnt(3)
    v_mfma_f32_32x32x16_bf16 v[40:55], v[208:211], v[88:91], v[40:55]
    s_cmp_gt_u32 s61, 22
    s_cselect_b32 s40, s58, s3
    s_add_u32 m0, s57, 73728
    s_add_u32 s40, s40, 360448
    buffer_load_dwordx4 v244, s[16:19], s40 offen lds
    ds_read_b128 v[88:91], v17 offset:28672
    s_waitcnt lgkmcnt(3)
    v_mfma_f32_32x32x16_bf16 v[40:55], v[212:215], v[92:95], v[40:55]
    s_cmp_gt_u32 s61, 23
    s_cselect_b32 s40, s58, s3
    s_add_u32 m0, s57, 77824
    s_add_u32 s40, s40, 376832
    buffer_load_dwordx4 v244, s[16:19], s40 offen lds
    ds_read_b128 v[92:95], v17 offset:29696
    s_waitcnt lgkmcnt(3)
    v_mfma_f32_32x32x16_bf16 v[40:55], v[216:219], v[96:99], v[40:55]
    s_cmp_gt_u32 s61, 24
    s_cselect_b32 s40, s58, s3
    s_add_u32 m0, s57, 81920
    s_add_u32 s40, s40, 393216
    buffer_load_dwordx4 v244, s[16:19], s40 offen lds
    ds_read_b128 v[96:99], v17 offset:30720
    s_waitcnt lgkmcnt(3)
    v_mfma_f32_32x32x16_bf16 v[40:55], v[220:223], v[100:103], v[40:55]
    s_cmp_gt_u32 s61, 25
    s_cselect_b32 s40, s58, s3
    s_add_u32 m0, s57, 86016
    s_add_u32 s40, s40, 409600
    buffer_load_dwordx4 v244, s[16:19], s40 offen lds
    ds_read_b128 v[100:103], v17 offset:31744
    s_waitcnt lgkmcnt(3)
    v_mfma_f32_32x32x16_bf16 v[40:55], v[224:227], v[88:91], v[40:55]
    s_cmp_gt_u32 s61, 26
    s_cselect_b32 s40, s58, s3
    s_add_u32 m0, s57, 90112
    s_add_u32 s40, s40, 425984
    buffer_load_dwordx4 v244, s[16:19], s40 offen lds
    s_waitcnt lgkmcnt(2)
    v_mfma_f32_32x32x16_bf16 v[40:55], v[228:231], v[92:95], v[40:55]
    s_cmp_gt_u32 s61, 27
    s_cselect_b32 s40, s58, s3
    s_add_u32 m0, s57, 94208
    s_add_u32 s40, s40, 442368
    buffer_load_dwordx4 v244, s[16:19], s40 offen lds
    s_waitcnt lgkmcnt(1)
    v_mfma_f32_32x32x16_bf16 v[40:55], v[232:235], v[96:99], v[40:55]
    s_waitcnt lgkmcnt(0)
    v_mfma_f32_32x32x16_bf16 v[40:55], v[236:239], v[100:103], v[40:55]
    v_and_b32 v20, 15, v0
    v_lshlrev_b32 v20, 4, v20
    v_and_b32 v21, 16, v0
    v_lshl_add_u32 v20, v21, 8, v20
    v_lshrrev_b32 v21, 5, v0
    v_lshl_add_u32 v20, v21, 10, v20
    s_lshl_b32 s45, s34, 2
    s_add_u32 s45, s45, 16384
    v_add_u32 v20, s45, v20
    s_nop 2
    v_cvt_pk_bf16_f32 v112, v40, v41
    v_cvt_pk_bf16_f32 v113, v42, v43
    v_cvt_pk_bf16_f32 v114, v44, v45
    v_cvt_pk_bf16_f32 v115, v46, v47
    v_cvt_pk_bf16_f32 v116, v48, v49
    v_cvt_pk_bf16_f32 v117, v50, v51
    v_cvt_pk_bf16_f32 v118, v52, v53
    v_cvt_pk_bf16_f32 v119, v54, v55
    s_nop 0
    v_mfma_f32_32x32x16_bf16 v[128:143], v[24:27], v[112:115], 0
    v_mfma_f32_32x32x16_bf16 v[128:143], v[28:31], v[116:119], v[128:143]
    v_mfma_f32_32x32x16_bf16 v[144:159], v[32:35], v[112:115], 0
    v_mfma_f32_32x32x16_bf16 v[144:159], v[36:39], v[116:119], v[144:159]
    s_nop 9
    v_permlane16_swap_b32 v128, v136
    v_permlane16_swap_b32 v129, v137
    v_permlane16_swap_b32 v130, v138
    v_permlane16_swap_b32 v131, v139
    v_permlane16_swap_b32 v132, v140
    v_permlane16_swap_b32 v133, v141
    v_permlane16_swap_b32 v134, v142
    v_permlane16_swap_b32 v135, v143
    v_permlane16_swap_b32 v144, v152
    v_permlane16_swap_b32 v145, v153
    v_permlane16_swap_b32 v146, v154
    v_permlane16_swap_b32 v147, v155
    v_permlane16_swap_b32 v148, v156
    v_permlane16_swap_b32 v149, v157
    v_permlane16_swap_b32 v150, v158
    v_permlane16_swap_b32 v151, v159
    v_add_f32 v128, v128, v152
    v_sub_f32 v136, v136, v144
    v_add_f32 v129, v129, v153
    v_sub_f32 v137, v137, v145
    v_add_f32 v130, v130, v154
    v_sub_f32 v138, v138, v146
    v_add_f32 v131, v131, v155
    v_sub_f32 v139, v139, v147
    v_add_f32 v132, v132, v156
    v_sub_f32 v140, v140, v148
    v_add_f32 v133, v133, v157
    v_sub_f32 v141, v141, v149
    v_add_f32 v134, v134, v158
    v_sub_f32 v142, v142, v150
    v_add_f32 v135, v135, v159
    v_sub_f32 v143, v143, v151
    v_cvt_pk_bf16_f32 v112, v128, v136
    v_cvt_pk_bf16_f32 v113, v129, v137
    v_cvt_pk_bf16_f32 v114, v130, v138
    v_cvt_pk_bf16_f32 v115, v131, v139
    v_cvt_pk_bf16_f32 v116, v132, v140
    v_cvt_pk_bf16_f32 v117, v133, v141
    v_cvt_pk_bf16_f32 v118, v134, v142
    v_cvt_pk_bf16_f32 v119, v135, v143
    ds_write_b32 v20, v112 offset:0
    ds_write_b32 v20, v113 offset:256
    ds_write_b32 v20, v114 offset:512
    ds_write_b32 v20, v115 offset:768
    ds_write_b32 v20, v116 offset:2048
    ds_write_b32 v20, v117 offset:2304
    ds_write_b32 v20, v118 offset:2560
    ds_write_b32 v20, v119 offset:2816
    s_waitcnt lgkmcnt(0)
    ds_write_b32 v246, v245 offset:96
    s_lshl_b32 s45, s34, 6
    v_add_u32 v16, s45, v0
    v_lshlrev_b32 v17, 4, v16
    v_lshrrev_b32 v18, 4, v16
    v_lshlrev_b32 v18, 16, v18
    v_and_b32 v19, 15, v16
    v_lshl_add_u32 v18, v19, 4, v18
    s_lshl_b32 s45, s36, 12
    s_lshl_b32 s46, s37, 8
    s_add_u32 s45, s45, s46
    s_add_u32 s45, s45, 6291456
    s_add_u32 s46, s45, 1048576
    v_mov_b32 v48, 163424
    s_mov_b32 s50, 1048576
    s_branch L_uw_first
L_uw:
    s_sleep 1
L_uw_first:
    ds_read_b128 v[40:43], v48
    s_sub_u32 s50, s50, 1
    s_cbranch_scc1 L_uw_out
    s_waitcnt lgkmcnt(0)
    v_and_b32 v40, v40, v41
    v_and_b32 v42, v42, v43
    v_and_b32 v40, v40, v42
    v_cmp_eq_u32 s[62:63], 0, v40
    s_cmp_lg_u64 s[62:63], 0
    s_cbranch_scc1 L_uw
L_uw_out:
    s_waitcnt lgkmcnt(0)
    ds_read_b128 v[112:115], v17 offset:16384
    ds_read_b128 v[116:119], v17 offset:20480
    s_waitcnt lgkmcnt(1)
    buffer_store_dwordx4 v[112:115], v18, s[20:23], s45 offen sc1
    s_waitcnt lgkmcnt(0)
    buffer_store_dwordx4 v[116:119], v18, s[20:23], s46 offen sc1
    s_cmp_ge_u32 s52, 4
    s_cselect_b32 s46, 0x80000000, 0
    s_or_b32 s46, s46, 0x3a000000
    v_and_b32 v16, 31, v0
    s_lshl_b32 s44, s53, 5
    s_add_u32 s44, s44, s51
    v_lshl_add_u32 v16, v16, 6, s44
    v_cvt_f32_u32 v16, v16
    v_mul_f32 v16, s46, v16
    v_lshrrev_b32 v17, 5, v0
    v_cvt_f32_u32 v18, v17
    v_mul_f32 v18, v18, v16
    v_mul_f32 v19, 0x42000000, v16
    v_cmp_gt_u32 vcc, 32, v0
    v_fmamk_f32 v20, v16, 0x0, v18
    v_add_f32 v21, v20, v19
    v_sub_f32 v22, v19, v20
    v_mul_f32 v23, 0.5, v19
    v_cndmask_b32 v22, v22, v23, vcc
    v_add_f32 v23, v22, v19
    v_cos_f32 v104, v20
    v_sin_f32 v105, v20
    v_cos_f32 v106, v21
    v_sin_f32 v107, v21
    v_cvt_pk_bf16_f32 v56, v104, v105
    v_cos_f32 v104, v22
    v_sin_f32 v105, v22
    v_cvt_pk_bf16_f32 v57, v106, v107
    v_cos_f32 v106, v23
    v_sin_f32 v107, v23
    v_cvt_pk_bf16_f32 v58, v104, v105
    s_nop 0
    v_cvt_pk_bf16_f32 v59, v106, v107
    v_fmamk_f32 v20, v16, 0x40000000, v18
    v_add_f32 v21, v20, v19
    v_sub_f32 v22, v19, v20
    v_add_f32 v23, v22, v19
    v_cos_f32 v104, v20
    v_sin_f32 v105, v20
    v_cos_f32 v106, v21
    v_sin_f32 v107, v21
    v_cvt_pk_bf16_f32 v60, v104, v105
    v_cos_f32 v104, v22
    v_sin_f32 v105, v22
    v_cvt_pk_bf16_f32 v61, v106, v107
    v_cos_f32 v106, v23
    v_sin_f32 v107, v23
    v_cvt_pk_bf16_f32 v62, v104, v105
    s_nop 0
    v_cvt_pk_bf16_f32 v63, v106, v107
    v_fmamk_f32 v20, v16, 0x40800000, v18
    v_add_f32 v21, v20, v19
    v_sub_f32 v22, v19, v20
    v_add_f32 v23, v22, v19
    v_cos_f32 v104, v20
    v_sin_f32 v105, v20
    v_cos_f32 v106, v21
    v_sin_f32 v107, v21
    v_cvt_pk_bf16_f32 v64, v104, v105
    v_cos_f32 v104, v22
    v_sin_f32 v105, v22
    v_cvt_pk_bf16_f32 v65, v106, v107
    v_cos_f32 v106, v23
    v_sin_f32 v107, v23
    v_cvt_pk_bf16_f32 v66, v104, v105
    s_nop 0
    v_cvt_pk_bf16_f32 v67, v106, v107
    v_fmamk_f32 v20, v16, 0x40c00000, v18
    v_add_f32 v21, v20, v19
    v_sub_f32 v22, v19, v20
    v_add_f32 v23, v22, v19
    v_cos_f32 v104, v20
    v_sin_f32 v105, v20
    v_cos_f32 v106, v21
    v_sin_f32 v107, v21
    v_cvt_pk_bf16_f32 v68, v104, v105
    v_cos_f32 v104, v22
    v_sin_f32 v105, v22
    v_cvt_pk_bf16_f32 v69, v106, v107
    v_cos_f32 v106, v23
    v_sin_f32 v107, v23
    v_cvt_pk_bf16_f32 v70, v104, v105
    s_nop 0
    v_cvt_pk_bf16_f32 v71, v106, v107
    v_mov_b32 v240, v16
    v_mov_b32 v241, v18
    v_mov_b32 v242, v19
    v_bfe_u32 v16, v0, 2, 1
    v_bfe_u32 v19, v0, 3, 2
    v_and_b32 v18, 3, v0
    v_lshl_add_u32 v18, v16, 4, v18
    v_lshl_add_u32 v18, v19, 2, v18
    s_lshl_b32 s44, s52, 6
    s_lshl_b32 s45, s54, 5
    s_add_u32 s44, s44, s45
    v_add_u32 v18, s44, v18
    v_cmp_eq_u32 vcc, 0, v18
    s_sub_u32 s45, 32, s51
    s_and_b32 s45, s45, 31
    s_cmp_ge_u32 s52, 4
    s_cselect_b32 s45, s45, s51
    s_cselect_b32 s47, -1, 0
    v_xor_b32 v18, s47, v18
    v_subrev_u32 v18, s47, v18
    v_and_b32 v18, 255, v18
    v_lshlrev_b32 v18, 4, v18
    v_lshrrev_b32 v17, 5, v0
    v_lshl_add_u32 v18, v17, 12, v18
    v_mov_b32 v19, 0x7ff00000
    s_bfe_u32 s46, s45, 0x20002
    s_lshl_b32 s46, s46, 11
    s_add_u32 s46, s46, 8650752
    s_lshl_b32 s48, s45, 16
    s_add_u32 s48, s48, 6291456
    v_cndmask_b32 v18, v18, v19, vcc
    s_lshl_b32 s44, s53, 1
    s_add_u32 s44, s44, s54
    s_lshl_b32 s44, s44, 12
    s_add_u32 s44, s44, 122880
    v_lshl_add_u32 v16, v0, 4, s44
    s_lshl_b32 s45, s34, 4
    s_add_u32 s45, s45, s37
    s_lshl_b32 s45, s45, 5
    s_add_u32 s45, s45, s36
    s_lshl_b32 s45, s45, 2
    s_add_u32 s45, s45, 8650752
    s_waitcnt vmcnt(0)
    v_mov_b32 v40, s49
    v_mov_b32 v41, 0
    s_mov_b64 exec, 1
    buffer_store_dword v40, v41, s[20:23], s45 offen sc1
    s_mov_b64 exec, -1
    ds_write_b32 v246, v245 offset:80
    v_fmamk_f32 v20, v240, 0x41000000, v241
    v_add_f32 v21, v20, v242
    v_sub_f32 v22, v242, v20
    v_add_f32 v23, v22, v242
    v_cos_f32 v104, v20
    v_sin_f32 v105, v20
    v_cos_f32 v106, v21
    v_sin_f32 v107, v21
    v_cvt_pk_bf16_f32 v72, v104, v105
    v_cos_f32 v104, v22
    v_sin_f32 v105, v22
    v_cvt_pk_bf16_f32 v73, v106, v107
    v_cos_f32 v106, v23
    v_sin_f32 v107, v23
    v_cvt_pk_bf16_f32 v74, v104, v105
    s_nop 0
    v_cvt_pk_bf16_f32 v75, v106, v107
    v_fmamk_f32 v20, v240, 0x41200000, v241
    v_add_f32 v21, v20, v242
    v_sub_f32 v22, v242, v20
    v_add_f32 v23, v22, v242
    v_cos_f32 v104, v20
    v_sin_f32 v105, v20
    v_cos_f32 v106, v21
    v_sin_f32 v107, v21
    v_cvt_pk_bf16_f32 v76, v104, v105
    v_cos_f32 v104, v22
    v_sin_f32 v105, v22
    v_cvt_pk_bf16_f32 v77, v106, v107
    v_cos_f32 v106, v23
    v_sin_f32 v107, v23
    v_cvt_pk_bf16_f32 v78, v104, v105
    s_nop 0
    v_cvt_pk_bf16_f32 v79, v106, v107
    v_fmamk_f32 v20, v240, 0x41400000, v241
    v_add_f32 v21, v20, v242
    v_sub_f32 v22, v242, v20
    v_add_f32 v23, v22, v242
    v_cos_f32 v104, v20
    v_sin_f32 v105, v20
    v_cos_f32 v106, v21
    v_sin_f32 v107, v21
    v_cvt_pk_bf16_f32 v80, v104, v105
    v_cos_f32 v104, v22
    v_sin_f32 v105, v22
    v_cvt_pk_bf16_f32 v81, v106, v107
    v_cos_f32 v106, v23
    v_sin_f32 v107, v23
    v_cvt_pk_bf16_f32 v82, v104, v105
    s_nop 0
    v_cvt_pk_bf16_f32 v83, v106, v107
    v_fmamk_f32 v20, v240, 0x41600000, v241
    v_add_f32 v21, v20, v242
    v_sub_f32 v22, v242, v20
    v_add_f32 v23, v22, v242
    v_cos_f32 v104, v20
    v_sin_f32 v105, v20
    v_cos_f32 v106, v21
    v_sin_f32 v107, v21
    v_cvt_pk_bf16_f32 v84, v104, v105
    v_cos_f32 v104, v22
    v_sin_f32 v105, v22
    v_cvt_pk_bf16_f32 v85, v106, v107
    v_cos_f32 v106, v23
    v_sin_f32 v107, v23
    v_cvt_pk_bf16_f32 v86, v104, v105
    s_nop 0
    v_cvt_pk_bf16_f32 v87, v106, v107
    s_cmp_eq_u32 s33, 5
    s_cbranch_scc0 L_upoll_other
    s_xor_b32 s44, s52, s47
    s_and_b32 s44, s44, 3
    s_lshl_b32 s44, s44, 9
    v_lshrrev_b32 v92, 4, v0
    v_lshl_add_u32 v92, v92, 7, s44
    v_and_b32 v93, 15, v0
    v_lshl_add_u32 v92, v93, 2, v92
    s_add_u32 s44, s44, 512
    s_and_b32 s44, s44, 2047
    v_lshl_add_u32 v93, v93, 2, s44
    v_mov_b32 v48, 163440
    s_mov_b32 s50, 1048576
    s_branch L_go_first
L_go:
    s_sleep 3
L_go_first:
    ds_read_b128 v[40:43], v48
    s_sub_u32 s50, s50, 1
    s_cbranch_scc1 L_go_out
    s_waitcnt lgkmcnt(0)
    v_and_b32 v40, v40, v41
    v_and_b32 v42, v42, v43
    v_and_b32 v40, v40, v42
    v_cmp_eq_u32 s[62:63], 0, v40
    s_cmp_lg_u64 s[62:63], 0
    s_cbranch_scc1 L_go
L_go_out:
    s_waitcnt lgkmcnt(0)
    s_mov_b32 s50, 1048576
L_upoll:
    buffer_load_dword v88, v92, s[20:23], s46 offen sc1
    s_mov_b64 exec, 0xffff
    buffer_load_dword v89, v93, s[20:23], s46 offen sc1
    s_mov_b64 exec, -1
    s_sub_u32 s50, s50, 1
    s_cbranch_scc1 L_upoll_out
    s_waitcnt vmcnt(0)
    v_cmp_ne_u32 s[62:63], s49, v89
    v_cmp_ne_u32 vcc, s49, v88
    s_and_b32 s62, s62, 0xffff
    s_or_b32 s62, s62, vcc_lo
    s_or_b32 s62, s62, vcc_hi
    s_cbranch_scc0 L_upoll_out
    s_sleep 8
    s_branch L_upoll
L_upoll_out:
    s_waitcnt vmcnt(0)
    v_mov_b32 v88, 163456
    v_mov_b32 v90, 1
    v_mov_b32 v91, 1
    ds_write_b64 v88, v[90:91]
    ds_write_b64 v88, v[90:91] offset:8
L_upoll_other:
    v_mov_b32 v48, 163456
    s_mov_b32 s50, 1048576
    s_branch L_ug_first
L_ug:
    s_sleep 3
L_ug_first:
    ds_read_b128 v[40:43], v48
    s_sub_u32 s50, s50, 1
    s_cbranch_scc1 L_ug_out
    s_waitcnt lgkmcnt(0)
    v_and_b32 v40, v40, v41
    v_and_b32 v42, v42, v43
    v_and_b32 v40, v40, v42
    v_cmp_eq_u32 s[62:63], 0, v40
    s_cmp_lg_u64 s[62:63], 0
    s_cbranch_scc1 L_ug
L_ug_out:
    s_waitcnt lgkmcnt(0)
    buffer_load_dwordx4 v[160:163], v18, s[20:23], s48 offen sc1
    s_add_u32 s48, s48, 8192
    buffer_load_dwordx4 v[164:167], v18, s[20:23], s48 offen sc1
    s_add_u32 s48, s48, 8192
    buffer_load_dwordx4 v[168:171], v18, s[20:23], s48 offen sc1
    s_add_u32 s48, s48, 8192
    buffer_load_dwordx4 v[172:175], v18, s[20:23], s48 offen sc1
    s_add_u32 s48, s48, 8192
    buffer_load_dwordx4 v[176:179], v18, s[20:23], s48 offen sc1
    s_add_u32 s48, s48, 8192
    buffer_load_dwordx4 v[180:183], v18, s[20:23], s48 offen sc1
    s_add_u32 s48, s48, 8192
    buffer_load_dwordx4 v[184:187], v18, s[20:23], s48 offen sc1
    s_add_u32 s48, s48, 8192
    buffer_load_dwordx4 v[188:191], v18, s[20:23], s48 offen sc1
    s_waitcnt vmcnt(7)
    v_mfma_f32_32x32x16_bf16 v[208:223], v[160:163], v[56:59], 0
    s_waitcnt vmcnt(6)
    v_mfma_f32_32x32x16_bf16 v[208:223], v[164:167], v[60:63], v[208:223]
    s_waitcnt vmcnt(5)
    v_mfma_f32_32x32x16_bf16 v[208:223], v[168:171], v[64:67], v[208:223]
    s_waitcnt vmcnt(4)
    v_mfma_f32_32x32x16_bf16 v[208:223], v[172:175], v[68:71], v[208:223]
    s_waitcnt vmcnt(3)
    v_mfma_f32_32x32x16_bf16 v[208:223], v[176:179], v[72:75], v[208:223]
    s_waitcnt vmcnt(2)
    v_mfma_f32_32x32x16_bf16 v[208:223], v[180:183], v[76:79], v[208:223]
    s_waitcnt vmcnt(1)
    v_mfma_f32_32x32x16_bf16 v[208:223], v[184:187], v[80:83], v[208:223]
    s_waitcnt vmcnt(0)
    v_mfma_f32_32x32x16_bf16 v[208:223], v[188:191], v[84:87], v[208:223]
    s_nop 11
    ds_write_b128 v16, v[208:211] offset:0
    ds_write_b128 v16, v[212:215] offset:1024
    ds_write_b128 v16, v[216:219] offset:2048
    ds_write_b128 v16, v[220:223] offset:3072
    s_waitcnt lgkmcnt(0)
    s_barrier
    s_lshl_b32 s44, s2, 3
    s_add_u32 s44, s44, s33
    s_cmp_eq_u32 s44, 6
    s_cbranch_scc0 L_end
    v_lshrrev_b32 v44, 4, v0
    v_lshlrev_b32 v44, 7, v44
    v_and_b32 v45, 15, v0
    v_lshl_add_u32 v44, v45, 2, v44
    s_mov_b32 s50, 1048576
L_apoll:
    s_mov_b32 s44, 8650752
    buffer_load_dword v40, v44, s[20:23], s44 offen sc1
    s_mov_b32 s44, 8651264
    buffer_load_dword v41, v44, s[20:23], s44 offen sc1
    s_mov_b32 s44, 8651776
    buffer_load_dword v42, v44, s[20:23], s44 offen sc1
    s_mov_b32 s44, 8652288
    buffer_load_dword v43, v44, s[20:23], s44 offen sc1
    s_sub_u32 s50, s50, 1
    s_cbranch_scc1 L_end
    s_waitcnt vmcnt(0)
    v_xor_b32 v40, s49, v40
    v_xor_b32 v41, s49, v41
    v_xor_b32 v42, s49, v42
    v_xor_b32 v43, s49, v43
    v_or3_b32 v40, v40, v41, v42
    v_or_b32 v40, v40, v43
    v_cmp_ne_u32 vcc, 0, v40
    s_cbranch_vccnz L_apoll
    s_mov_b32 s45, 8781824
    v_mov_b32 v40, s49
    v_mov_b32 v41, 0
    s_mov_b64 exec, 1
    buffer_store_dword v40, v41, s[20:23], s45 offen sc1
    s_mov_b64 exec, -1
    s_endpgm
L_compute:
    s_lshr_b32 s44, s37, 2
    s_mov_b32 s45, s36
    s_sub_u32 s46, 32, s36
    s_cmp_eq_u32 s36, 0
    s_cselect_b32 s46, 16, s46
    s_cmp_ge_u32 s44, 2
    s_cselect_b32 s45, s46, s45
    s_and_b32 s46, s44, 1
    s_lshl_b32 s46, s46, 5
    s_add_u32 s45, s45, s46
    s_lshl_b32 s45, s45, 10
    s_and_b32 s46, s37, 3
    s_lshl_b32 s46, s46, 2
    s_add_u32 s46, s46, s33
    s_lshl_b32 s46, s46, 1
    s_lshl_b32 s47, s46, 16
    s_add_u32 s45, s45, s47
    v_lshrrev_b32 v17, 5, v0
    v_and_b32 v16, 31, v0
    v_lshlrev_b32 v18, 5, v16
    v_lshl_add_u32 v18, v17, 16, v18
    s_waitcnt lgkmcnt(0)
    s_add_u32 s62, s20, 8781824
    s_addc_u32 s63, s21, 0
    s_load_dword s49, s[62:63], 0
    s_and_b32 s9, s9, 0xffff
    s_mov_b32 s10, 2097152
    s_mov_b32 s11, 0x20000
    buffer_load_dwordx4 v[72:75], v18, s[8:11], s45 offen
    buffer_load_dwordx4 v[76:79], v18, s[8:11], s45 offen offset:16
    s_lshl_b32 s45, s36, 2
    s_add_u32 s45, s45, s44
    s_lshl_b32 s45, s45, 5
    s_add_u32 s45, s45, s46
    s_lshl_b32 s45, s45, 4
    s_add_u32 s48, s45, 8847360
    s_mov_b32 s3, 1409024
    s_cmp_ge_u32 s33, 2
    s_cselect_b32 s12, s8, s16
    s_cselect_b32 s13, s9, s17
    s_cselect_b32 s44, 32, 22
    s_cselect_b32 s14, 2097152, s3
    s_and_b32 s13, s13, 0xffff
    s_mov_b32 s15, 0x20000
    s_lshl_b32 s41, s2, 1
    s_add_u32 s41, s41, s53
    s_mul_i32 s41, s41, s44
    s_lshl_b32 s41, s41, 7
    v_lshlrev_b32 v18, 7, v0
    v_mov_b32 v19, 0x7ff00000
    v_cmp_gt_u32 vcc, s44, v0
    s_nop 1
    v_cndmask_b32 v13, v19, v18, vcc
    s_and_b32 s21, s21, 0xffff
    s_mov_b32 s22, 9175040
    s_mov_b32 s23, 0x20000
    s_and_b32 s25, s25, 0xffff
    s_mov_b32 s26, 2097152
    s_mov_b32 s27, 0x20000
    s_and_b32 s56, s2, 7
    s_lshl_b32 s56, s56, 1
    s_lshr_b32 s44, s2, 7
    s_add_u32 s56, s56, s44
    s_bfe_u32 s55, s2, 0x10006
    s_bfe_u32 s52, s2, 0x30003
    s_mov_b32 s44, s56
    s_sub_u32 s45, 32, s56
    s_cmp_eq_u32 s56, 0
    s_cselect_b32 s45, 16, s45
    s_cmp_eq_u32 s55, 0
    s_cselect_b32 s51, s44, s45
    v_mov_b32 v245, 1
    s_lshl_b32 s44, s34, 2
    s_add_u32 s44, s44, 163328
    v_mov_b32 v246, s44
    s_and_b32 s17, s17, 0xffff
    s_mov_b32 s18, 1409024
    s_mov_b32 s19, 0x20000
    v_bfe_u32 v18, v0, 1, 3
    v_xor_b32 v18, v18, v17
    v_lshlrev_b32 v16, 7, v16
    v_lshl_add_u32 v16, v18, 4, v16
    s_lshl_b32 s44, s53, 13
    v_add_u32 v1, s44, v16
    v_xor_b32 v2, 32, v1
    v_xor_b32 v3, 64, v1
    v_xor_b32 v4, 96, v1
    v_bfe_u32 v16, v0, 4, 1
    v_bfe_u32 v18, v0, 2, 2
    v_lshl_add_u32 v18, v17, 3, v18
    v_mul_u32_u24 v18, 192, v18
    v_mul_u32_u24 v19, 12320, v16
    v_add_u32 v18, v18, v19
    v_and_b32 v19, 1, v0
    v_lshl_add_u32 v18, v19, 4, v18
    v_bfe_u32 v19, v0, 1, 1
    v_lshl_add_u32 v18, v19, 3, v18
    s_lshl_b32 s46, s36, 2
    s_lshl_b32 s45, s53, 1
    s_add_u32 s46, s46, s45
    s_mul_i32 s46, s46, 86
    s_add_u32 s46, s46, s39
    s_add_u32 s46, s46, 4
    s_cmp_eq_u32 s54, 0
    s_cselect_b32 s44, 1, 3
    s_add_u32 s28, s46, s44
    s_lshl_b32 s28, s28, 10
    s_and_b32 s45, s44, 1
    s_lshl_b32 s45, s45, 5
    v_xor_b32 v19, s45, v18
    s_lshr_b32 s44, s44, 1
    s_lshl_b32 s44, s44, 6
    s_add_u32 s44, s44, 49152
    v_add_u32 v5, s44, v19
    s_cmp_eq_u32 s54, 0
    s_cselect_b32 s44, 2, 4
    s_add_u32 s29, s46, s44
    s_lshl_b32 s29, s29, 10
    s_and_b32 s45, s44, 1
    s_lshl_b32 s45, s45, 5
    v_xor_b32 v19, s45, v18
    s_lshr_b32 s44, s44, 1
    s_lshl_b32 s44, s44, 6
    s_add_u32 s44, s44, 49152
    v_add_u32 v6, s44, v19
    s_cmp_eq_u32 s54, 0
    s_cselect_b32 s44, 0, 5
    s_add_u32 s30, s46, s44
    s_lshl_b32 s30, s30, 10
    s_and_b32 s45, s44, 1
    s_lshl_b32 s45, s45, 5
    v_xor_b32 v19, s45, v18
    s_lshr_b32 s44, s44, 1
    s_lshl_b32 s44, s44, 6
    s_add_u32 s44, s44, 49152
    v_add_u32 v7, s44, v19
    v_mov_b32 v19, 0
    v_lshlrev_b32 v18, 2, v0
    v_add_u32 v18, 163328, v18
    ds_write_b32 v18, v19
    v_and_b32 v18, 15, v0
    s_lshl_b32 s44, s37, 4
    v_add_u32 v18, s44, v18
    v_cmp_eq_u32 vcc, 0, v18
    v_mov_b32 v19, 0x100
    v_cvt_f32_u32 v16, v16
    v_cndmask_b32 v18, v18, v19, vcc
    v_cvt_f32_u32 v18, v18
    v_mul_f32 v18, 0x3b000000, v18
    v_mul_f32 v16, 0x3e800000, v16
    s_lshl_b32 s44, s33, 13
    s_add_u32 s44, s44, 122880
    v_lshl_add_u32 v21, v0, 4, s44
    s_lshl_b32 s44, s33, 1
    s_add_u32 s44, s44, s59
    s_add_u32 s44, s44, 0
    s_and_b32 s44, s44, 7
    s_lshl_b32 s44, s44, 6
    v_lshl_add_u32 v22, v17, 3, s44
    v_cvt_f32_u32 v22, v22
    v_fma_f32 v22, v22, v18, v16
    v_cos_f32 v40, v22
    v_fmamk_f32 v20, v18, 0x3f800000, v22
    v_cos_f32 v41, v20
    v_fmamk_f32 v19, v18, 0x40000000, v22
    v_cos_f32 v42, v19
    v_fmamk_f32 v20, v18, 0x40400000, v22
    v_cos_f32 v43, v20
    v_fmamk_f32 v19, v18, 0x40800000, v22
    v_cos_f32 v44, v19
    v_fmamk_f32 v20, v18, 0x40a00000, v22
    v_cos_f32 v45, v20
    v_fmamk_f32 v19, v18, 0x40c00000, v22
    v_cos_f32 v46, v19
    v_fmamk_f32 v20, v18, 0x40e00000, v22
    v_cos_f32 v47, v20
    s_nop 0
    v_cvt_pk_bf16_f32 v48, v40, v41
    v_cvt_pk_bf16_f32 v49, v42, v43
    v_cvt_pk_bf16_f32 v50, v44, v45
    v_cvt_pk_bf16_f32 v51, v46, v47
    ds_write_b128 v21, v[48:51] offset:0
    v_fmamk_f32 v19, v18, 0x41800000, v22
    v_cos_f32 v40, v19
    v_fmamk_f32 v20, v18, 0x41880000, v22
    v_cos_f32 v41, v20
    v_fmamk_f32 v19, v18, 0x41900000, v22
    v_cos_f32 v42, v19
    v_fmamk_f32 v20, v18, 0x41980000, v22
    v_cos_f32 v43, v20
    v_fmamk_f32 v19, v18, 0x41a00000, v22
    v_cos_f32 v44, v19
    v_fmamk_f32 v20, v18, 0x41a80000, v22
    v_cos_f32 v45, v20
    v_fmamk_f32 v19, v18, 0x41b00000, v22
    v_cos_f32 v46, v19
    v_fmamk_f32 v20, v18, 0x41b80000, v22
    v_cos_f32 v47, v20
    s_nop 0
    v_cvt_pk_bf16_f32 v52, v40, v41
    v_cvt_pk_bf16_f32 v53, v42, v43
    v_cvt_pk_bf16_f32 v54, v44, v45
    v_cvt_pk_bf16_f32 v55, v46, v47
    ds_write_b128 v21, v[52:55] offset:1024
    v_fmamk_f32 v19, v18, 0x42000000, v22
    v_cos_f32 v40, v19
    v_fmamk_f32 v20, v18, 0x42040000, v22
    v_cos_f32 v41, v20
    v_fmamk_f32 v19, v18, 0x42080000, v22
    v_cos_f32 v42, v19
    v_fmamk_f32 v20, v18, 0x420c0000, v22
    v_cos_f32 v43, v20
    v_fmamk_f32 v19, v18, 0x42100000, v22
    v_cos_f32 v44, v19
    v_fmamk_f32 v20, v18, 0x42140000, v22
    v_cos_f32 v45, v20
    v_fmamk_f32 v19, v18, 0x42180000, v22
    v_cos_f32 v46, v19
    v_fmamk_f32 v20, v18, 0x421c0000, v22
    v_cos_f32 v47, v20
    s_nop 0
    v_cvt_pk_bf16_f32 v48, v40, v41
    v_cvt_pk_bf16_f32 v49, v42, v43
    v_cvt_pk_bf16_f32 v50, v44, v45
    v_cvt_pk_bf16_f32 v51, v46, v47
    ds_write_b128 v21, v[48:51] offset:2048
    v_fmamk_f32 v19, v18, 0x42400000, v22
    v_cos_f32 v40, v19
    v_fmamk_f32 v20, v18, 0x42440000, v22
    v_cos_f32 v41, v20
    v_fmamk_f32 v19, v18, 0x42480000, v22
    v_cos_f32 v42, v19
    v_fmamk_f32 v20, v18, 0x424c0000, v22
    v_cos_f32 v43, v20
    v_fmamk_f32 v19, v18, 0x42500000, v22
    v_cos_f32 v44, v19
    v_fmamk_f32 v20, v18, 0x42540000, v22
    v_cos_f32 v45, v20
    v_fmamk_f32 v19, v18, 0x42580000, v22
    v_cos_f32 v46, v19
    v_fmamk_f32 v20, v18, 0x425c0000, v22
    v_cos_f32 v47, v20
    s_nop 0
    v_cvt_pk_bf16_f32 v52, v40, v41
    v_cvt_pk_bf16_f32 v53, v42, v43
    v_cvt_pk_bf16_f32 v54, v44, v45
    v_cvt_pk_bf16_f32 v55, v46, v47
    ds_write_b128 v21, v[52:55] offset:3072
    buffer_load_dword v247, v13, s[12:15], s41 offen
    s_waitcnt vmcnt(1)
    v_lshlrev_b32 v80, 16, v72
    v_and_b32 v81, 0xffff0000, v72
    v_mov_b32 v19, v80
    v_mov_b32 v200, v81
    v_mul_f32 v20, v80, v80
    v_mul_f32 v201, v81, v81
    v_lshlrev_b32 v80, 16, v73
    v_and_b32 v81, 0xffff0000, v73
    v_add_f32 v19, v19, v80
    v_add_f32 v200, v200, v81
    v_fmac_f32 v20, v80, v80
    v_fmac_f32 v201, v81, v81
    v_lshlrev_b32 v80, 16, v74
    v_and_b32 v81, 0xffff0000, v74
    v_add_f32 v19, v19, v80
    v_add_f32 v200, v200, v81
    v_fmac_f32 v20, v80, v80
    v_fmac_f32 v201, v81, v81
    v_lshlrev_b32 v80, 16, v75
    v_and_b32 v81, 0xffff0000, v75
    v_add_f32 v19, v19, v80
    v_add_f32 v200, v200, v81
    v_fmac_f32 v20, v80, v80
    v_fmac_f32 v201, v81, v81
    v_lshlrev_b32 v80, 16, v76
    v_and_b32 v81, 0xffff0000, v76
    v_add_f32 v19, v19, v80
    v_add_f32 v200, v200, v81
    v_fmac_f32 v20, v80, v80
    v_fmac_f32 v201, v81, v81
    v_lshlrev_b32 v80, 16, v77
    v_and_b32 v81, 0xffff0000, v77
    v_add_f32 v19, v19, v80
    v_add_f32 v200, v200, v81
    v_fmac_f32 v20, v80, v80
    v_fmac_f32 v201, v81, v81
    v_lshlrev_b32 v80, 16, v78
    v_and_b32 v81, 0xffff0000, v78
    v_add_f32 v19, v19, v80
    v_add_f32 v200, v200, v81
    v_fmac_f32 v20, v80, v80
    v_fmac_f32 v201, v81, v81
    v_lshlrev_b32 v80, 16, v79
    v_and_b32 v81, 0xffff0000, v79
    v_add_f32 v19, v19, v80
    v_add_f32 v200, v200, v81
    v_fmac_f32 v20, v80, v80
    v_fmac_f32 v201, v81, v81
    v_add_f32 v19, v19, v200
    v_add_f32 v20, v20, v201
    s_nop 0
    v_add_f32_dpp v19, v19, v19 row_shr:1
    v_add_f32_dpp v20, v20, v20 row_shr:1
    s_nop 0
    v_add_f32_dpp v19, v19, v19 row_shr:2
    v_add_f32_dpp v20, v20, v20 row_shr:2
    s_nop 0
    v_add_f32_dpp v19, v19, v19 row_shr:4
    v_add_f32_dpp v20, v20, v20 row_shr:4
    s_nop 0
    v_add_f32_dpp v19, v19, v19 row_shr:8
    v_add_f32_dpp v20, v20, v20 row_shr:8
    s_nop 0
    v_add_f32_dpp v19, v19, v19 row_bcast:15 row_mask:0xa
    v_add_f32_dpp v20, v20, v20 row_bcast:15 row_mask:0xa
    v_mul_f32 v200, 0xbb000000, v19
    v_mul_f32 v20, 0x3b000000, v20
    v_fma_f32 v20, -v200, v200, v20
    v_max_f32 v20, 0, v20
    v_add_f32 v20, 0x3727c5ac, v20
    v_rcp_f32 v201, v20
    v_rsq_f32 v202, v20
    v_lshlrev_b32 v19, 4, v17
    s_waitcnt lgkmcnt(0)
    s_add_u32 s49, s49, 0x9e3779b9
    s_mov_b32 exec_lo, 0x80000000
    s_mov_b32 exec_hi, 0x80000000
    v_mov_b32 v203, s49
    buffer_store_dwordx4 v[200:203], v19, s[20:23], s48 offen sc1
    s_mov_b64 exec, -1
    s_lshl_b32 s44, s33, 1
    s_add_u32 s44, s44, s59
    s_add_u32 s44, s44, 1
    s_and_b32 s44, s44, 7
    s_lshl_b32 s44, s44, 6
    v_lshl_add_u32 v22, v17, 3, s44
    v_cvt_f32_u32 v22, v22
    v_fma_f32 v22, v22, v18, v16
    v_cos_f32 v40, v22
    v_fmamk_f32 v20, v18, 0x3f800000, v22
    v_cos_f32 v41, v20
    v_fmamk_f32 v19, v18, 0x40000000, v22
    v_cos_f32 v42, v19
    v_fmamk_f32 v20, v18, 0x40400000, v22
    v_cos_f32 v43, v20
    v_fmamk_f32 v19, v18, 0x40800000, v22
    v_cos_f32 v44, v19
    v_fmamk_f32 v20, v18, 0x40a00000, v22
    v_cos_f32 v45, v20
    v_fmamk_f32 v19, v18, 0x40c00000, v22
    v_cos_f32 v46, v19
    v_fmamk_f32 v20, v18, 0x40e00000, v22
    v_cos_f32 v47, v20
    s_nop 0
    v_cvt_pk_bf16_f32 v48, v40, v41
    v_cvt_pk_bf16_f32 v49, v42, v43
    v_cvt_pk_bf16_f32 v50, v44, v45
    v_cvt_pk_bf16_f32 v51, v46, v47
    ds_write_b128 v21, v[48:51] offset:4096
    v_fmamk_f32 v19, v18, 0x41800000, v22
    v_cos_f32 v40, v19
    v_fmamk_f32 v20, v18, 0x41880000, v22
    v_cos_f32 v41, v20
    v_fmamk_f32 v19, v18, 0x41900000, v22
    v_cos_f32 v42, v19
    v_fmamk_f32 v20, v18, 0x41980000, v22
    v_cos_f32 v43, v20
    v_fmamk_f32 v19, v18, 0x41a00000, v22
    v_cos_f32 v44, v19
    v_fmamk_f32 v20, v18, 0x41a80000, v22
    v_cos_f32 v45, v20
    v_fmamk_f32 v19, v18, 0x41b00000, v22
    v_cos_f32 v46, v19
    v_fmamk_f32 v20, v18, 0x41b80000, v22
    v_cos_f32 v47, v20
    s_nop 0
    v_cvt_pk_bf16_f32 v52, v40, v41
    v_cvt_pk_bf16_f32 v53, v42, v43
    v_cvt_pk_bf16_f32 v54, v44, v45
    v_cvt_pk_bf16_f32 v55, v46, v47
    ds_write_b128 v21, v[52:55] offset:5120
    v_fmamk_f32 v19, v18, 0x42000000, v22
    v_cos_f32 v40, v19
    v_fmamk_f32 v20, v18, 0x42040000, v22
    v_cos_f32 v41, v20
    v_fmamk_f32 v19, v18, 0x42080000, v22
    v_cos_f32 v42, v19
    v_fmamk_f32 v20, v18, 0x420c0000, v22
    v_cos_f32 v43, v20
    v_fmamk_f32 v19, v18, 0x42100000, v22
    v_cos_f32 v44, v19
    v_fmamk_f32 v20, v18, 0x42140000, v22
    v_cos_f32 v45, v20
    v_fmamk_f32 v19, v18, 0x42180000, v22
    v_cos_f32 v46, v19
    v_fmamk_f32 v20, v18, 0x421c0000, v22
    v_cos_f32 v47, v20
    s_nop 0
    v_cvt_pk_bf16_f32 v48, v40, v41
    v_cvt_pk_bf16_f32 v49, v42, v43
    v_cvt_pk_bf16_f32 v50, v44, v45
    v_cvt_pk_bf16_f32 v51, v46, v47
    ds_write_b128 v21, v[48:51] offset:6144
    v_fmamk_f32 v19, v18, 0x42400000, v22
    v_cos_f32 v40, v19
    v_fmamk_f32 v20, v18, 0x42440000, v22
    v_cos_f32 v41, v20
    v_fmamk_f32 v19, v18, 0x42480000, v22
    v_cos_f32 v42, v19
    v_fmamk_f32 v20, v18, 0x424c0000, v22
    v_cos_f32 v43, v20
    v_fmamk_f32 v19, v18, 0x42500000, v22
    v_cos_f32 v44, v19
    v_fmamk_f32 v20, v18, 0x42540000, v22
    v_cos_f32 v45, v20
    v_fmamk_f32 v19, v18, 0x42580000, v22
    v_cos_f32 v46, v19
    v_fmamk_f32 v20, v18, 0x425c0000, v22
    v_cos_f32 v47, v20
    s_nop 0
    v_cvt_pk_bf16_f32 v52, v40, v41
    v_cvt_pk_bf16_f32 v53, v42, v43
    v_cvt_pk_bf16_f32 v54, v44, v45
    v_cvt_pk_bf16_f32 v55, v46, v47
    ds_write_b128 v21, v[52:55] offset:7168
    s_lshl_b32 s60, s36, 1
    s_add_u32 s60, s60, s53
    s_lshl_b32 s60, s60, 4
    s_add_u32 s60, s60, s37
    s_lshl_b32 s60, s60, 1
    s_add_u32 s60, s60, s54
    s_lshl_b32 s60, s60, 7
    s_add_u32 s60, s60, 8388608
    v_lshrrev_b32 v16, 3, v0
    v_bfe_u32 v17, v0, 4, 1
    v_lshlrev_b32 v17, 2, v17
    v_and_b32 v18, 7, v0
    v_xor_b32 v17, v17, v18
    v_lshlrev_b32 v16, 10, v16
    v_lshl_add_u32 v244, v17, 4, v16
    s_lshl_b32 s57, s54, 11
    s_lshl_b32 s44, s53, 10
    s_add_u32 s57, s57, s44
    s_mul_i32 s58, s54, 704512
    s_lshl_b32 s44, s53, 13
    s_add_u32 s58, s58, s44
    s_lshl_b32 s44, s52, 7
    s_add_u32 s58, s58, s44
    s_mul_i32 s44, s52, 5
    s_sub_u32 s61, 43, s44
    s_lshl_b32 s44, s44, 14
    s_add_u32 s58, s58, s44
    s_sub_u32 s3, s58, 704512
    s_lshl_b32 s48, s36, 2
    s_lshl_b32 s44, s53, 1
    s_add_u32 s48, s48, s44
    s_lshl_b32 s48, s48, 9
    s_add_u32 s48, s48, 8847360
    v_and_b32 v12, 31, v0
    v_lshlrev_b32 v12, 4, v12
    s_sub_u32 s44, 1, s54
    s_lshl_b32 s44, 0x1249, s44
    s_lshr_b32 s44, s44, s37
    s_and_b32 s44, s44, 1
    s_mov_b32 s45, 0
    s_mov_b64 vcc, s[44:45]
    s_waitcnt lgkmcnt(0)
    s_barrier
    ds_read_b64_tr_b16 v[176:177], v7 offset:0
    ds_read_b64_tr_b16 v[178:179], v7 offset:768
    ds_read_b128 v[136:139], v1 offset:0
    ds_read_b128 v[140:143], v1 offset:4096
    ds_read_b64_tr_b16 v[168:169], v5 offset:0
    ds_read_b64_tr_b16 v[170:171], v5 offset:768
    ds_read_b64_tr_b16 v[172:173], v6 offset:0
    ds_read_b64_tr_b16 v[174:175], v6 offset:768
    s_waitcnt lgkmcnt(4)
    s_cbranch_vccnz L_opt_0
    v_mfma_f32_32x32x16_bf16 v[104:119], v[176:179], v[136:139], 0
    ds_read_b64_tr_b16 v[188:189], v7 offset:3072
    ds_read_b64_tr_b16 v[190:191], v7 offset:3840
    v_mfma_f32_32x32x16_bf16 v[120:135], v[176:179], v[140:143], 0
L_opt_0:
    s_waitcnt lgkmcnt(2)
    v_mfma_f32_32x32x16_bf16 v[40:55], v[168:171], v[136:139], 0
    ds_read_b128 v[144:147], v2 offset:0
    ds_read_b128 v[148:151], v2 offset:4096
    ds_read_b64_tr_b16 v[180:181], v5 offset:3072
    v_mfma_f32_32x32x16_bf16 v[56:71], v[168:171], v[140:143], 0
    ds_read_b64_tr_b16 v[182:183], v5 offset:3840
    ds_read_b64_tr_b16 v[184:185], v6 offset:3072
    ds_read_b64_tr_b16 v[186:187], v6 offset:3840
    s_waitcnt lgkmcnt(6)
    v_mfma_f32_32x32x16_bf16 v[72:87], v[172:175], v[136:139], 0
    v_mfma_f32_32x32x16_bf16 v[88:103], v[172:175], v[140:143], 0
    s_waitcnt lgkmcnt(4)
    s_cbranch_vccnz L_opt_1
    v_mfma_f32_32x32x16_bf16 v[104:119], v[188:191], v[144:147], v[104:119]
    ds_read_b64_tr_b16 v[176:177], v7 offset:6144
    ds_read_b64_tr_b16 v[178:179], v7 offset:6912
    v_mfma_f32_32x32x16_bf16 v[120:135], v[188:191], v[148:151], v[120:135]
L_opt_1:
    s_waitcnt lgkmcnt(2)
    v_mfma_f32_32x32x16_bf16 v[40:55], v[180:183], v[144:147], v[40:55]
    ds_read_b128 v[136:139], v3 offset:0
    ds_read_b128 v[140:143], v3 offset:4096
    ds_read_b64_tr_b16 v[168:169], v5 offset:6144
    v_mfma_f32_32x32x16_bf16 v[56:71], v[180:183], v[148:151], v[56:71]
    ds_read_b64_tr_b16 v[170:171], v5 offset:6912
    ds_read_b64_tr_b16 v[172:173], v6 offset:6144
    ds_read_b64_tr_b16 v[174:175], v6 offset:6912
    s_waitcnt lgkmcnt(6)
    v_mfma_f32_32x32x16_bf16 v[72:87], v[184:187], v[144:147], v[72:87]
    v_mfma_f32_32x32x16_bf16 v[88:103], v[184:187], v[148:151], v[88:103]
    s_waitcnt lgkmcnt(4)
    s_cbranch_vccnz L_opt_2
    v_mfma_f32_32x32x16_bf16 v[104:119], v[176:179], v[136:139], v[104:119]
    ds_read_b64_tr_b16 v[188:189], v7 offset:9216
    ds_read_b64_tr_b16 v[190:191], v7 offset:9984
    v_mfma_f32_32x32x16_bf16 v[120:135], v[176:179], v[140:143], v[120:135]
L_opt_2:
    s_waitcnt lgkmcnt(2)
    v_mfma_f32_32x32x16_bf16 v[40:55], v[168:171], v[136:139], v[40:55]
    ds_read_b128 v[144:147], v4 offset:0
    ds_read_b128 v[148:151], v4 offset:4096
    ds_read_b64_tr_b16 v[180:181], v5 offset:9216
    v_mfma_f32_32x32x16_bf16 v[56:71], v[168:171], v[140:143], v[56:71]
    ds_read_b64_tr_b16 v[182:183], v5 offset:9984
    ds_read_b64_tr_b16 v[184:185], v6 offset:9216
    ds_read_b64_tr_b16 v[186:187], v6 offset:9984
    s_waitcnt lgkmcnt(6)
    v_mfma_f32_32x32x16_bf16 v[72:87], v[172:175], v[136:139], v[72:87]
    v_mfma_f32_32x32x16_bf16 v[88:103], v[172:175], v[140:143], v[88:103]
    s_waitcnt lgkmcnt(4)
    s_cbranch_vccnz L_opt_3
    v_mfma_f32_32x32x16_bf16 v[104:119], v[188:191], v[144:147], v[104:119]
    v_mfma_f32_32x32x16_bf16 v[120:135], v[188:191], v[148:151], v[120:135]
L_opt_3:
    s_waitcnt lgkmcnt(0)
    s_barrier
    v_mfma_f32_32x32x16_bf16 v[40:55], v[180:183], v[144:147], v[40:55]
    ds_read_b64_tr_b16 v[176:177], v7 offset:24576
    ds_read_b64_tr_b16 v[178:179], v7 offset:25344
    ds_read_b128 v[136:139], v1 offset:16384
    v_mfma_f32_32x32x16_bf16 v[56:71], v[180:183], v[148:151], v[56:71]
    ds_read_b128 v[140:143], v1 offset:20480
    ds_read_b64_tr_b16 v[168:169], v5 offset:24576
    ds_read_b64_tr_b16 v[170:171], v5 offset:25344
    v_mfma_f32_32x32x16_bf16 v[72:87], v[184:187], v[144:147], v[72:87]
    ds_read_b64_tr_b16 v[172:173], v6 offset:24576
    ds_read_b64_tr_b16 v[174:175], v6 offset:25344
    v_mfma_f32_32x32x16_bf16 v[88:103], v[184:187], v[148:151], v[88:103]
    s_waitcnt lgkmcnt(4)
    s_cbranch_vccnz L_opt_4
    v_mfma_f32_32x32x16_bf16 v[104:119], v[176:179], v[136:139], v[104:119]
    ds_read_b64_tr_b16 v[188:189], v7 offset:27648
    ds_read_b64_tr_b16 v[190:191], v7 offset:28416
    v_mfma_f32_32x32x16_bf16 v[120:135], v[176:179], v[140:143], v[120:135]
L_opt_4:
    s_waitcnt lgkmcnt(2)
    v_mfma_f32_32x32x16_bf16 v[40:55], v[168:171], v[136:139], v[40:55]
    ds_read_b128 v[144:147], v2 offset:16384
    ds_read_b128 v[148:151], v2 offset:20480
    ds_read_b64_tr_b16 v[180:181], v5 offset:27648
    v_mfma_f32_32x32x16_bf16 v[56:71], v[168:171], v[140:143], v[56:71]
    ds_read_b64_tr_b16 v[182:183], v5 offset:28416
    ds_read_b64_tr_b16 v[184:185], v6 offset:27648
    ds_read_b64_tr_b16 v[186:187], v6 offset:28416
    s_waitcnt lgkmcnt(6)
    v_mfma_f32_32x32x16_bf16 v[72:87], v[172:175], v[136:139], v[72:87]
    v_mfma_f32_32x32x16_bf16 v[88:103], v[172:175], v[140:143], v[88:103]
    s_waitcnt lgkmcnt(4)
    s_cbranch_vccnz L_opt_5
    v_mfma_f32_32x32x16_bf16 v[104:119], v[188:191], v[144:147], v[104:119]
    ds_read_b64_tr_b16 v[176:177], v7 offset:30720
    ds_read_b64_tr_b16 v[178:179], v7 offset:31488
    v_mfma_f32_32x32x16_bf16 v[120:135], v[188:191], v[148:151], v[120:135]
L_opt_5:
    s_waitcnt lgkmcnt(2)
    v_mfma_f32_32x32x16_bf16 v[40:55], v[180:183], v[144:147], v[40:55]
    ds_read_b128 v[136:139], v3 offset:16384
    ds_read_b128 v[140:143], v3 offset:20480
    ds_read_b64_tr_b16 v[168:169], v5 offset:30720
    v_mfma_f32_32x32x16_bf16 v[56:71], v[180:183], v[148:151], v[56:71]
    ds_read_b64_tr_b16 v[170:171], v5 offset:31488
    ds_read_b64_tr_b16 v[172:173], v6 offset:30720
    ds_read_b64_tr_b16 v[174:175], v6 offset:31488
    s_waitcnt lgkmcnt(6)
    v_mfma_f32_32x32x16_bf16 v[72:87], v[184:187], v[144:147], v[72:87]
    v_mfma_f32_32x32x16_bf16 v[88:103], v[184:187], v[148:151], v[88:103]
    s_waitcnt lgkmcnt(4)
    s_cbranch_vccnz L_opt_6
    v_mfma_f32_32x32x16_bf16 v[104:119], v[176:179], v[136:139], v[104:119]
    ds_read_b64_tr_b16 v[188:189], v7 offset:33792
    ds_read_b64_tr_b16 v[190:191], v7 offset:34560
    v_mfma_f32_32x32x16_bf16 v[120:135], v[176:179], v[140:143], v[120:135]
L_opt_6:
    s_waitcnt lgkmcnt(2)
    v_mfma_f32_32x32x16_bf16 v[40:55], v[168:171], v[136:139], v[40:55]
    ds_read_b128 v[144:147], v4 offset:16384
    ds_read_b128 v[148:151], v4 offset:20480
    ds_read_b64_tr_b16 v[180:181], v5 offset:33792
    v_mfma_f32_32x32x16_bf16 v[56:71], v[168:171], v[140:143], v[56:71]
    ds_read_b64_tr_b16 v[182:183], v5 offset:34560
    ds_read_b64_tr_b16 v[184:185], v6 offset:33792
    ds_read_b64_tr_b16 v[186:187], v6 offset:34560
    s_waitcnt lgkmcnt(6)
    v_mfma_f32_32x32x16_bf16 v[72:87], v[172:175], v[136:139], v[72:87]
    v_mfma_f32_32x32x16_bf16 v[88:103], v[172:175], v[140:143], v[88:103]
    s_waitcnt lgkmcnt(4)
    s_cbranch_vccnz L_opt_7
    v_mfma_f32_32x32x16_bf16 v[104:119], v[188:191], v[144:147], v[104:119]
    v_mfma_f32_32x32x16_bf16 v[120:135], v[188:191], v[148:151], v[120:135]
L_opt_7:
    s_waitcnt lgkmcnt(0)
    s_barrier
    v_mfma_f32_32x32x16_bf16 v[40:55], v[180:183], v[144:147], v[40:55]
    ds_read_b64_tr_b16 v[176:177], v7 offset:49152
    ds_read_b64_tr_b16 v[178:179], v7 offset:49920
    ds_read_b128 v[136:139], v1 offset:32768
    v_mfma_f32_32x32x16_bf16 v[56:71], v[180:183], v[148:151], v[56:71]
    ds_read_b128 v[140:143], v1 offset:36864
    ds_read_b64_tr_b16 v[168:169], v5 offset:49152
    ds_read_b64_tr_b16 v[170:171], v5 offset:49920
    v_mfma_f32_32x32x16_bf16 v[72:87], v[184:187], v[144:147], v[72:87]
    ds_read_b64_tr_b16 v[172:173], v6 offset:49152
    ds_read_b64_tr_b16 v[174:175], v6 offset:49920
    v_mfma_f32_32x32x16_bf16 v[88:103], v[184:187], v[148:151], v[88:103]
    s_waitcnt lgkmcnt(4)
    s_cbranch_vccnz L_opt_8
    v_mfma_f32_32x32x16_bf16 v[104:119], v[176:179], v[136:139], v[104:119]
    ds_read_b64_tr_b16 v[188:189], v7 offset:52224
    ds_read_b64_tr_b16 v[190:191], v7 offset:52992
    v_mfma_f32_32x32x16_bf16 v[120:135], v[176:179], v[140:143], v[120:135]
L_opt_8:
    s_waitcnt lgkmcnt(2)
    v_mfma_f32_32x32x16_bf16 v[40:55], v[168:171], v[136:139], v[40:55]
    ds_read_b128 v[144:147], v2 offset:32768
    ds_read_b128 v[148:151], v2 offset:36864
    ds_read_b64_tr_b16 v[180:181], v5 offset:52224
    v_mfma_f32_32x32x16_bf16 v[56:71], v[168:171], v[140:143], v[56:71]
    ds_read_b64_tr_b16 v[182:183], v5 offset:52992
    ds_read_b64_tr_b16 v[184:185], v6 offset:52224
    ds_read_b64_tr_b16 v[186:187], v6 offset:52992
    s_waitcnt lgkmcnt(6)
    v_mfma_f32_32x32x16_bf16 v[72:87], v[172:175], v[136:139], v[72:87]
    v_mfma_f32_32x32x16_bf16 v[88:103], v[172:175], v[140:143], v[88:103]
    s_waitcnt lgkmcnt(4)
    s_cbranch_vccnz L_opt_9
    v_mfma_f32_32x32x16_bf16 v[104:119], v[188:191], v[144:147], v[104:119]
    ds_read_b64_tr_b16 v[176:177], v7 offset:55296
    ds_read_b64_tr_b16 v[178:179], v7 offset:56064
    v_mfma_f32_32x32x16_bf16 v[120:135], v[188:191], v[148:151], v[120:135]
L_opt_9:
    s_waitcnt lgkmcnt(2)
    v_mfma_f32_32x32x16_bf16 v[40:55], v[180:183], v[144:147], v[40:55]
    ds_read_b128 v[136:139], v3 offset:32768
    ds_read_b128 v[140:143], v3 offset:36864
    ds_read_b64_tr_b16 v[168:169], v5 offset:55296
    v_mfma_f32_32x32x16_bf16 v[56:71], v[180:183], v[148:151], v[56:71]
    ds_read_b64_tr_b16 v[170:171], v5 offset:56064
    ds_read_b64_tr_b16 v[172:173], v6 offset:55296
    ds_read_b64_tr_b16 v[174:175], v6 offset:56064
    s_waitcnt lgkmcnt(6)
    v_mfma_f32_32x32x16_bf16 v[72:87], v[184:187], v[144:147], v[72:87]
    v_mfma_f32_32x32x16_bf16 v[88:103], v[184:187], v[148:151], v[88:103]
    s_waitcnt lgkmcnt(4)
    s_cbranch_vccnz L_opt_10
    v_mfma_f32_32x32x16_bf16 v[104:119], v[176:179], v[136:139], v[104:119]
    ds_read_b64_tr_b16 v[188:189], v7 offset:58368
    ds_read_b64_tr_b16 v[190:191], v7 offset:59136
    v_mfma_f32_32x32x16_bf16 v[120:135], v[176:179], v[140:143], v[120:135]
L_opt_10:
    s_waitcnt lgkmcnt(2)
    v_mfma_f32_32x32x16_bf16 v[40:55], v[168:171], v[136:139], v[40:55]
    ds_read_b128 v[144:147], v4 offset:32768
    ds_read_b128 v[148:151], v4 offset:36864
    ds_read_b64_tr_b16 v[180:181], v5 offset:58368
    v_mfma_f32_32x32x16_bf16 v[56:71], v[168:171], v[140:143], v[56:71]
    ds_read_b64_tr_b16 v[182:183], v5 offset:59136
    ds_read_b64_tr_b16 v[184:185], v6 offset:58368
    ds_read_b64_tr_b16 v[186:187], v6 offset:59136
    s_waitcnt lgkmcnt(6)
    v_mfma_f32_32x32x16_bf16 v[72:87], v[172:175], v[136:139], v[72:87]
    v_mfma_f32_32x32x16_bf16 v[88:103], v[172:175], v[140:143], v[88:103]
    s_waitcnt lgkmcnt(4)
    s_cbranch_vccnz L_opt_11
    v_mfma_f32_32x32x16_bf16 v[104:119], v[188:191], v[144:147], v[104:119]
    v_mfma_f32_32x32x16_bf16 v[120:135], v[188:191], v[148:151], v[120:135]
L_opt_11:
    s_waitcnt lgkmcnt(0)
    s_barrier
    v_mfma_f32_32x32x16_bf16 v[40:55], v[180:183], v[144:147], v[40:55]
    ds_read_b64_tr_b16 v[176:177], v7 offset:0
    ds_read_b64_tr_b16 v[178:179], v7 offset:768
    ds_read_b128 v[136:139], v1 offset:0
    v_mfma_f32_32x32x16_bf16 v[56:71], v[180:183], v[148:151], v[56:71]
    ds_read_b128 v[140:143], v1 offset:4096
    ds_read_b64_tr_b16 v[168:169], v5 offset:0
    ds_read_b64_tr_b16 v[170:171], v5 offset:768
    v_mfma_f32_32x32x16_bf16 v[72:87], v[184:187], v[144:147], v[72:87]
    ds_read_b64_tr_b16 v[172:173], v6 offset:0
    ds_read_b64_tr_b16 v[174:175], v6 offset:768
    v_mfma_f32_32x32x16_bf16 v[88:103], v[184:187], v[148:151], v[88:103]
    s_waitcnt lgkmcnt(4)
    s_cbranch_vccnz L_opt_12
    v_mfma_f32_32x32x16_bf16 v[104:119], v[176:179], v[136:139], v[104:119]
    ds_read_b64_tr_b16 v[188:189], v7 offset:3072
    ds_read_b64_tr_b16 v[190:191], v7 offset:3840
    v_mfma_f32_32x32x16_bf16 v[120:135], v[176:179], v[140:143], v[120:135]
L_opt_12:
    s_waitcnt lgkmcnt(2)
    v_mfma_f32_32x32x16_bf16 v[40:55], v[168:171], v[136:139], v[40:55]
    ds_read_b128 v[144:147], v2 offset:0
    ds_read_b128 v[148:151], v2 offset:4096
    ds_read_b64_tr_b16 v[180:181], v5 offset:3072
    v_mfma_f32_32x32x16_bf16 v[56:71], v[168:171], v[140:143], v[56:71]
    ds_read_b64_tr_b16 v[182:183], v5 offset:3840
    ds_read_b64_tr_b16 v[184:185], v6 offset:3072
    ds_read_b64_tr_b16 v[186:187], v6 offset:3840
    s_waitcnt lgkmcnt(6)
    v_mfma_f32_32x32x16_bf16 v[72:87], v[172:175], v[136:139], v[72:87]
    v_mfma_f32_32x32x16_bf16 v[88:103], v[172:175], v[140:143], v[88:103]
    s_waitcnt lgkmcnt(4)
    s_cbranch_vccnz L_opt_13
    v_mfma_f32_32x32x16_bf16 v[104:119], v[188:191], v[144:147], v[104:119]
    ds_read_b64_tr_b16 v[176:177], v7 offset:6144
    ds_read_b64_tr_b16 v[178:179], v7 offset:6912
    v_mfma_f32_32x32x16_bf16 v[120:135], v[188:191], v[148:151], v[120:135]
L_opt_13:
    s_waitcnt lgkmcnt(2)
    v_mfma_f32_32x32x16_bf16 v[40:55], v[180:183], v[144:147], v[40:55]
    ds_read_b128 v[136:139], v3 offset:0
    ds_read_b128 v[140:143], v3 offset:4096
    ds_read_b64_tr_b16 v[168:169], v5 offset:6144
    v_mfma_f32_32x32x16_bf16 v[56:71], v[180:183], v[148:151], v[56:71]
    ds_read_b64_tr_b16 v[170:171], v5 offset:6912
    ds_read_b64_tr_b16 v[172:173], v6 offset:6144
    ds_read_b64_tr_b16 v[174:175], v6 offset:6912
    s_waitcnt lgkmcnt(6)
    v_mfma_f32_32x32x16_bf16 v[72:87], v[184:187], v[144:147], v[72:87]
    v_mfma_f32_32x32x16_bf16 v[88:103], v[184:187], v[148:151], v[88:103]
    s_waitcnt lgkmcnt(4)
    s_cbranch_vccnz L_opt_14
    v_mfma_f32_32x32x16_bf16 v[104:119], v[176:179], v[136:139], v[104:119]
    ds_read_b64_tr_b16 v[188:189], v7 offset:9216
    ds_read_b64_tr_b16 v[190:191], v7 offset:9984
    v_mfma_f32_32x32x16_bf16 v[120:135], v[176:179], v[140:143], v[120:135]
L_opt_14:
    s_waitcnt lgkmcnt(2)
    v_mfma_f32_32x32x16_bf16 v[40:55], v[168:171], v[136:139], v[40:55]
    ds_read_b128 v[144:147], v4 offset:0
    ds_read_b128 v[148:151], v4 offset:4096
    ds_read_b64_tr_b16 v[180:181], v5 offset:9216
    v_mfma_f32_32x32x16_bf16 v[56:71], v[168:171], v[140:143], v[56:71]
    ds_read_b64_tr_b16 v[182:183], v5 offset:9984
    ds_read_b64_tr_b16 v[184:185], v6 offset:9216
    ds_read_b64_tr_b16 v[186:187], v6 offset:9984
    s_waitcnt lgkmcnt(6)
    v_mfma_f32_32x32x16_bf16 v[72:87], v[172:175], v[136:139], v[72:87]
    v_mfma_f32_32x32x16_bf16 v[88:103], v[172:175], v[140:143], v[88:103]
    s_waitcnt lgkmcnt(4)
    s_cbranch_vccnz L_opt_15
    v_mfma_f32_32x32x16_bf16 v[104:119], v[188:191], v[144:147], v[104:119]
    v_mfma_f32_32x32x16_bf16 v[120:135], v[188:191], v[148:151], v[120:135]
L_opt_15:
    s_waitcnt lgkmcnt(0)
    s_barrier
    v_mfma_f32_32x32x16_bf16 v[40:55], v[180:183], v[144:147], v[40:55]
    ds_read_b64_tr_b16 v[176:177], v7 offset:24576
    ds_read_b64_tr_b16 v[178:179], v7 offset:25344
    ds_read_b128 v[136:139], v1 offset:16384
    v_mfma_f32_32x32x16_bf16 v[56:71], v[180:183], v[148:151], v[56:71]
    ds_read_b128 v[140:143], v1 offset:20480
    ds_read_b64_tr_b16 v[168:169], v5 offset:24576
    ds_read_b64_tr_b16 v[170:171], v5 offset:25344
    v_mfma_f32_32x32x16_bf16 v[72:87], v[184:187], v[144:147], v[72:87]
    ds_read_b64_tr_b16 v[172:173], v6 offset:24576
    ds_read_b64_tr_b16 v[174:175], v6 offset:25344
    v_mfma_f32_32x32x16_bf16 v[88:103], v[184:187], v[148:151], v[88:103]
    s_waitcnt lgkmcnt(4)
    s_cbranch_vccnz L_opt_16
    v_mfma_f32_32x32x16_bf16 v[104:119], v[176:179], v[136:139], v[104:119]
    ds_read_b64_tr_b16 v[188:189], v7 offset:27648
    ds_read_b64_tr_b16 v[190:191], v7 offset:28416
    v_mfma_f32_32x32x16_bf16 v[120:135], v[176:179], v[140:143], v[120:135]
L_opt_16:
    s_waitcnt lgkmcnt(2)
    v_mfma_f32_32x32x16_bf16 v[40:55], v[168:171], v[136:139], v[40:55]
    ds_read_b128 v[144:147], v2 offset:16384
    ds_read_b128 v[148:151], v2 offset:20480
    ds_read_b64_tr_b16 v[180:181], v5 offset:27648
    v_mfma_f32_32x32x16_bf16 v[56:71], v[168:171], v[140:143], v[56:71]
    ds_read_b64_tr_b16 v[182:183], v5 offset:28416
    ds_read_b64_tr_b16 v[184:185], v6 offset:27648
    ds_read_b64_tr_b16 v[186:187], v6 offset:28416
    s_waitcnt lgkmcnt(6)
    v_mfma_f32_32x32x16_bf16 v[72:87], v[172:175], v[136:139], v[72:87]
    v_mfma_f32_32x32x16_bf16 v[88:103], v[172:175], v[140:143], v[88:103]
    s_waitcnt lgkmcnt(4)
    s_cbranch_vccnz L_opt_17
    v_mfma_f32_32x32x16_bf16 v[104:119], v[188:191], v[144:147], v[104:119]
    ds_read_b64_tr_b16 v[176:177], v7 offset:30720
    ds_read_b64_tr_b16 v[178:179], v7 offset:31488
    v_mfma_f32_32x32x16_bf16 v[120:135], v[188:191], v[148:151], v[120:135]
L_opt_17:
    s_waitcnt lgkmcnt(2)
    v_mfma_f32_32x32x16_bf16 v[40:55], v[180:183], v[144:147], v[40:55]
    ds_read_b128 v[136:139], v3 offset:16384
    ds_read_b128 v[140:143], v3 offset:20480
    ds_read_b64_tr_b16 v[168:169], v5 offset:30720
    v_mfma_f32_32x32x16_bf16 v[56:71], v[180:183], v[148:151], v[56:71]
    ds_read_b64_tr_b16 v[170:171], v5 offset:31488
    ds_read_b64_tr_b16 v[172:173], v6 offset:30720
    ds_read_b64_tr_b16 v[174:175], v6 offset:31488
    s_waitcnt lgkmcnt(6)
    v_mfma_f32_32x32x16_bf16 v[72:87], v[184:187], v[144:147], v[72:87]
    v_mfma_f32_32x32x16_bf16 v[88:103], v[184:187], v[148:151], v[88:103]
    buffer_load_dwordx4 v[200:203], v12, s[20:23], s48 offen sc1
    buffer_load_dwordx4 v[204:207], v12, s[20:23], s48 offen offset:512 sc1
    s_lshl_b32 s44, s54, 9
    s_add_u32 s44, s44, 155648
    v_lshrrev_b32 v17, 5, v0
    v_lshl_add_u32 v17, v17, 11, v12
    v_add_u32 v17, s44, v17
    v_lshlrev_b32 v18, 4, v0
    v_add_u32 v19, 88064, v18
    s_waitcnt lgkmcnt(4)
    s_cbranch_vccnz L_opt_18
    v_mfma_f32_32x32x16_bf16 v[104:119], v[176:179], v[136:139], v[104:119]
    ds_read_b64_tr_b16 v[188:189], v7 offset:33792
    ds_read_b64_tr_b16 v[190:191], v7 offset:34560
    v_mfma_f32_32x32x16_bf16 v[120:135], v[176:179], v[140:143], v[120:135]
L_opt_18:
    s_waitcnt lgkmcnt(2)
    v_mfma_f32_32x32x16_bf16 v[40:55], v[168:171], v[136:139], v[40:55]
    ds_read_b128 v[144:147], v4 offset:16384
    ds_read_b128 v[148:151], v4 offset:20480
    ds_read_b64_tr_b16 v[180:181], v5 offset:33792
    v_mfma_f32_32x32x16_bf16 v[56:71], v[168:171], v[140:143], v[56:71]
    ds_read_b64_tr_b16 v[182:183], v5 offset:34560
    ds_read_b64_tr_b16 v[184:185], v6 offset:33792
    ds_read_b64_tr_b16 v[186:187], v6 offset:34560
    s_waitcnt lgkmcnt(6)
    v_mfma_f32_32x32x16_bf16 v[72:87], v[172:175], v[136:139], v[72:87]
    v_mfma_f32_32x32x16_bf16 v[88:103], v[172:175], v[140:143], v[88:103]
    s_waitcnt lgkmcnt(4)
    s_cbranch_vccnz L_opt_19
    v_mfma_f32_32x32x16_bf16 v[104:119], v[188:191], v[144:147], v[104:119]
    v_mfma_f32_32x32x16_bf16 v[120:135], v[188:191], v[148:151], v[120:135]
L_opt_19:
    s_waitcnt lgkmcnt(0)
    s_barrier
    v_mfma_f32_32x32x16_bf16 v[40:55], v[180:183], v[144:147], v[40:55]
    ds_read_b64_tr_b16 v[176:177], v7 offset:49152
    ds_read_b64_tr_b16 v[178:179], v7 offset:49920
    ds_read_b128 v[136:139], v1 offset:32768
    v_mfma_f32_32x32x16_bf16 v[56:71], v[180:183], v[148:151], v[56:71]
    ds_read_b128 v[140:143], v1 offset:36864
    ds_read_b64_tr_b16 v[168:169], v5 offset:49152
    ds_read_b64_tr_b16 v[170:171], v5 offset:49920
    v_mfma_f32_32x32x16_bf16 v[72:87], v[184:187], v[144:147], v[72:87]
    ds_read_b64_tr_b16 v[172:173], v6 offset:49152
    ds_read_b64_tr_b16 v[174:175], v6 offset:49920
    v_mfma_f32_32x32x16_bf16 v[88:103], v[184:187], v[148:151], v[88:103]
    s_waitcnt lgkmcnt(4)
    s_cbranch_vccnz L_opt_20
    v_mfma_f32_32x32x16_bf16 v[104:119], v[176:179], v[136:139], v[104:119]
    ds_read_b64_tr_b16 v[188:189], v7 offset:52224
    ds_read_b64_tr_b16 v[190:191], v7 offset:52992
    v_mfma_f32_32x32x16_bf16 v[120:135], v[176:179], v[140:143], v[120:135]
L_opt_20:
    s_waitcnt lgkmcnt(2)
    v_mfma_f32_32x32x16_bf16 v[40:55], v[168:171], v[136:139], v[40:55]
    ds_read_b128 v[144:147], v2 offset:32768
    ds_read_b128 v[148:151], v2 offset:36864
    ds_read_b64_tr_b16 v[180:181], v5 offset:52224
    v_mfma_f32_32x32x16_bf16 v[56:71], v[168:171], v[140:143], v[56:71]
    ds_read_b64_tr_b16 v[182:183], v5 offset:52992
    ds_read_b64_tr_b16 v[184:185], v6 offset:52224
    ds_read_b64_tr_b16 v[186:187], v6 offset:52992
    s_waitcnt lgkmcnt(6)
    v_mfma_f32_32x32x16_bf16 v[72:87], v[172:175], v[136:139], v[72:87]
    v_mfma_f32_32x32x16_bf16 v[88:103], v[172:175], v[140:143], v[88:103]
    s_waitcnt lgkmcnt(4)
    s_cbranch_vccnz L_opt_21
    v_mfma_f32_32x32x16_bf16 v[104:119], v[188:191], v[144:147], v[104:119]
    ds_read_b64_tr_b16 v[176:177], v7 offset:55296
    ds_read_b64_tr_b16 v[178:179], v7 offset:56064
    v_mfma_f32_32x32x16_bf16 v[120:135], v[188:191], v[148:151], v[120:135]
L_opt_21:
    s_waitcnt lgkmcnt(2)
    v_mfma_f32_32x32x16_bf16 v[40:55], v[180:183], v[144:147], v[40:55]
    ds_read_b128 v[136:139], v3 offset:32768
    ds_read_b128 v[140:143], v3 offset:36864
    ds_read_b64_tr_b16 v[168:169], v5 offset:55296
    v_mfma_f32_32x32x16_bf16 v[56:71], v[180:183], v[148:151], v[56:71]
    ds_read_b64_tr_b16 v[170:171], v5 offset:56064
    ds_read_b64_tr_b16 v[172:173], v6 offset:55296
    ds_read_b64_tr_b16 v[174:175], v6 offset:56064
    s_waitcnt lgkmcnt(6)
    v_mfma_f32_32x32x16_bf16 v[72:87], v[184:187], v[144:147], v[72:87]
    v_mfma_f32_32x32x16_bf16 v[88:103], v[184:187], v[148:151], v[88:103]
    s_waitcnt lgkmcnt(4)
    s_cbranch_vccnz L_opt_22
    v_mfma_f32_32x32x16_bf16 v[104:119], v[176:179], v[136:139], v[104:119]
    ds_read_b64_tr_b16 v[188:189], v7 offset:58368
    ds_read_b64_tr_b16 v[190:191], v7 offset:59136
    v_mfma_f32_32x32x16_bf16 v[120:135], v[176:179], v[140:143], v[120:135]
L_opt_22:
    s_waitcnt lgkmcnt(2)
    v_mfma_f32_32x32x16_bf16 v[40:55], v[168:171], v[136:139], v[40:55]
    ds_read_b128 v[144:147], v4 offset:32768
    ds_read_b128 v[148:151], v4 offset:36864
    ds_read_b64_tr_b16 v[180:181], v5 offset:58368
    v_mfma_f32_32x32x16_bf16 v[56:71], v[168:171], v[140:143], v[56:71]
    ds_read_b64_tr_b16 v[182:183], v5 offset:59136
    ds_read_b64_tr_b16 v[184:185], v6 offset:58368
    ds_read_b64_tr_b16 v[186:187], v6 offset:59136
    s_waitcnt lgkmcnt(6)
    v_mfma_f32_32x32x16_bf16 v[72:87], v[172:175], v[136:139], v[72:87]
    v_mfma_f32_32x32x16_bf16 v[88:103], v[172:175], v[140:143], v[88:103]
    s_waitcnt lgkmcnt(4)
    s_cbranch_vccnz L_opt_23
    v_mfma_f32_32x32x16_bf16 v[104:119], v[188:191], v[144:147], v[104:119]
    v_mfma_f32_32x32x16_bf16 v[120:135], v[188:191], v[148:151], v[120:135]
L_opt_23:
    s_waitcnt lgkmcnt(0)
    s_barrier
    v_mfma_f32_32x32x16_bf16 v[40:55], v[180:183], v[144:147], v[40:55]
    ds_read_b64_tr_b16 v[176:177], v7 offset:0
    ds_read_b64_tr_b16 v[178:179], v7 offset:768
    ds_read_b128 v[136:139], v1 offset:0
    v_mfma_f32_32x32x16_bf16 v[56:71], v[180:183], v[148:151], v[56:71]
    ds_read_b128 v[140:143], v1 offset:4096
    ds_read_b64_tr_b16 v[168:169], v5 offset:0
    ds_read_b64_tr_b16 v[170:171], v5 offset:768
    v_mfma_f32_32x32x16_bf16 v[72:87], v[184:187], v[144:147], v[72:87]
    ds_read_b64_tr_b16 v[172:173], v6 offset:0
    ds_read_b64_tr_b16 v[174:175], v6 offset:768
    v_mfma_f32_32x32x16_bf16 v[88:103], v[184:187], v[148:151], v[88:103]
    s_waitcnt lgkmcnt(4)
    s_cbranch_vccnz L_opt_24
    v_mfma_f32_32x32x16_bf16 v[104:119], v[176:179], v[136:139], v[104:119]
    ds_read_b64_tr_b16 v[188:189], v7 offset:3072
    ds_read_b64_tr_b16 v[190:191], v7 offset:3840
    v_mfma_f32_32x32x16_bf16 v[120:135], v[176:179], v[140:143], v[120:135]
L_opt_24:
    s_waitcnt lgkmcnt(2)
    v_mfma_f32_32x32x16_bf16 v[40:55], v[168:171], v[136:139], v[40:55]
    ds_read_b128 v[144:147], v2 offset:0
    ds_read_b128 v[148:151], v2 offset:4096
    ds_read_b64_tr_b16 v[180:181], v5 offset:3072
    v_mfma_f32_32x32x16_bf16 v[56:71], v[168:171], v[140:143], v[56:71]
    ds_read_b64_tr_b16 v[182:183], v5 offset:3840
    ds_read_b64_tr_b16 v[184:185], v6 offset:3072
    ds_read_b64_tr_b16 v[186:187], v6 offset:3840
    s_waitcnt lgkmcnt(6)
    v_mfma_f32_32x32x16_bf16 v[72:87], v[172:175], v[136:139], v[72:87]
    v_mfma_f32_32x32x16_bf16 v[88:103], v[172:175], v[140:143], v[88:103]
    s_waitcnt lgkmcnt(4)
    s_cbranch_vccnz L_opt_25
    v_mfma_f32_32x32x16_bf16 v[104:119], v[188:191], v[144:147], v[104:119]
    ds_read_b64_tr_b16 v[176:177], v7 offset:6144
    ds_read_b64_tr_b16 v[178:179], v7 offset:6912
    v_mfma_f32_32x32x16_bf16 v[120:135], v[188:191], v[148:151], v[120:135]
L_opt_25:
    s_waitcnt lgkmcnt(2)
    v_mfma_f32_32x32x16_bf16 v[40:55], v[180:183], v[144:147], v[40:55]
    ds_read_b128 v[136:139], v3 offset:0
    ds_read_b128 v[140:143], v3 offset:4096
    ds_read_b64_tr_b16 v[168:169], v5 offset:6144
    v_mfma_f32_32x32x16_bf16 v[56:71], v[180:183], v[148:151], v[56:71]
    ds_read_b64_tr_b16 v[170:171], v5 offset:6912
    ds_read_b64_tr_b16 v[172:173], v6 offset:6144
    ds_read_b64_tr_b16 v[174:175], v6 offset:6912
    s_waitcnt lgkmcnt(6)
    v_mfma_f32_32x32x16_bf16 v[72:87], v[184:187], v[144:147], v[72:87]
    v_mfma_f32_32x32x16_bf16 v[88:103], v[184:187], v[148:151], v[88:103]
    s_waitcnt vmcnt(0)
    s_mov_b32 s50, 1048576
L_cstat:
    v_cmp_ne_u32 s[62:63], s49, v203
    s_cmp_lg_u64 s[62:63], 0
    s_cbranch_scc1 L_cstat_again
    v_cmp_ne_u32 s[62:63], s49, v207
    s_cmp_lg_u64 s[62:63], 0
    s_cbranch_scc1 L_cstat_again
    s_branch L_cstat_out
L_cstat_again:
    buffer_load_dwordx4 v[200:203], v12, s[20:23], s48 offen sc1
    buffer_load_dwordx4 v[204:207], v12, s[20:23], s48 offen offset:512 sc1
    s_sub_u32 s50, s50, 1
    s_waitcnt vmcnt(0)
    s_cbranch_scc0 L_cstat
L_cstat_out:
    s_waitcnt lgkmcnt(4)
    s_cbranch_vccnz L_opt_26
    v_mfma_f32_32x32x16_bf16 v[104:119], v[176:179], v[136:139], v[104:119]
    ds_read_b64_tr_b16 v[188:189], v7 offset:9216
    ds_read_b64_tr_b16 v[190:191], v7 offset:9984
    v_mfma_f32_32x32x16_bf16 v[120:135], v[176:179], v[140:143], v[120:135]
L_opt_26:
    s_waitcnt lgkmcnt(2)
    v_mfma_f32_32x32x16_bf16 v[40:55], v[168:171], v[136:139], v[40:55]
    ds_read_b128 v[144:147], v4 offset:0
    ds_read_b128 v[148:151], v4 offset:4096
    ds_read_b64_tr_b16 v[180:181], v5 offset:9216
    v_mfma_f32_32x32x16_bf16 v[56:71], v[168:171], v[140:143], v[56:71]
    ds_read_b64_tr_b16 v[182:183], v5 offset:9984
    ds_read_b64_tr_b16 v[184:185], v6 offset:9216
    ds_read_b64_tr_b16 v[186:187], v6 offset:9984
    s_waitcnt lgkmcnt(6)
    v_mfma_f32_32x32x16_bf16 v[72:87], v[172:175], v[136:139], v[72:87]
    v_mfma_f32_32x32x16_bf16 v[88:103], v[172:175], v[140:143], v[88:103]
    s_waitcnt lgkmcnt(4)
    s_cbranch_vccnz L_opt_27
    v_mfma_f32_32x32x16_bf16 v[104:119], v[188:191], v[144:147], v[104:119]
    v_mfma_f32_32x32x16_bf16 v[120:135], v[188:191], v[148:151], v[120:135]
L_opt_27:
    s_waitcnt lgkmcnt(0)
    s_barrier
    v_mfma_f32_32x32x16_bf16 v[40:55], v[180:183], v[144:147], v[40:55]
    ds_read_b128 v[24:27], v17 offset:0
    ds_read_b128 v[28:31], v17 offset:1024
    ds_read_b128 v[152:155], v1 offset:16384
    v_mfma_f32_32x32x16_bf16 v[56:71], v[180:183], v[148:151], v[56:71]
    ds_read_b128 v[156:159], v1 offset:20480
    ds_read_b128 v[160:163], v2 offset:16384
    ds_read_b128 v[164:167], v2 offset:20480
    v_mfma_f32_32x32x16_bf16 v[72:87], v[184:187], v[144:147], v[72:87]
    ds_read_b128 v[136:139], v3 offset:16384
    ds_read_b128 v[140:143], v3 offset:20480
    v_mfma_f32_32x32x16_bf16 v[88:103], v[184:187], v[148:151], v[88:103]
    ds_read_b128 v[144:147], v4 offset:16384
    ds_read_b128 v[148:151], v4 offset:20480
    s_waitcnt lgkmcnt(6)
    ds_read_b64_tr_b16 v[168:169], v5 offset:24576
    ds_read_b64_tr_b16 v[170:171], v5 offset:25344
    ds_read_b64_tr_b16 v[172:173], v5 offset:27648
    ds_read_b64_tr_b16 v[174:175], v5 offset:28416
    ds_read_b64_tr_b16 v[176:177], v5 offset:30720
    ds_read_b64_tr_b16 v[178:179], v5 offset:31488
    ds_read_b64_tr_b16 v[180:181], v5 offset:33792
    ds_read_b64_tr_b16 v[182:183], v5 offset:34560
    v_add_f32 v24, v24, v28
    v_add_f32 v25, v25, v29
    v_add_f32 v26, v26, v30
    s_nop 1
    v_mfma_f32_32x32x2_f32 v[40:55], v24, v200, v[40:55]
    v_mfma_f32_32x32x2_f32 v[56:71], v24, v204, v[56:71]
    s_waitcnt lgkmcnt(6)
    v_mfma_f32_32x32x2_f32 v[72:87], v25, v200, v[72:87]
    ds_read_b64_tr_b16 v[184:185], v6 offset:24576
    ds_read_b64_tr_b16 v[186:187], v6 offset:25344
    v_mfma_f32_32x32x2_f32 v[88:103], v25, v204, v[88:103]
    ds_read_b64_tr_b16 v[188:189], v6 offset:27648
    ds_read_b64_tr_b16 v[190:191], v6 offset:28416
    v_mfma_f32_32x32x2_f32 v[104:119], v26, v200, v[104:119]
    ds_read_b64_tr_b16 v[192:193], v6 offset:30720
    ds_read_b64_tr_b16 v[194:195], v6 offset:31488
    v_mfma_f32_32x32x2_f32 v[120:135], v26, v204, v[120:135]
    ds_read_b64_tr_b16 v[196:197], v6 offset:33792
    ds_read_b64_tr_b16 v[198:199], v6 offset:34560
    s_waitcnt lgkmcnt(8)
    v_mfma_f32_32x32x16_bf16 v[40:55], v[168:171], v[152:155], v[40:55]
    v_mfma_f32_32x32x16_bf16 v[40:55], v[172:175], v[160:163], v[40:55]
    v_mfma_f32_32x32x16_bf16 v[40:55], v[176:179], v[136:139], v[40:55]
    v_mfma_f32_32x32x16_bf16 v[40:55], v[180:183], v[144:147], v[40:55]
    v_mfma_f32_32x32x16_bf16 v[56:71], v[168:171], v[156:159], v[56:71]
    v_mfma_f32_32x32x16_bf16 v[56:71], v[172:175], v[164:167], v[56:71]
    v_mfma_f32_32x32x16_bf16 v[56:71], v[176:179], v[140:143], v[56:71]
    v_mfma_f32_32x32x16_bf16 v[56:71], v[180:183], v[148:151], v[56:71]
    s_waitcnt lgkmcnt(0)
    s_cbranch_vccnz L_two
    v_mfma_f32_32x32x16_bf16 v[72:87], v[184:187], v[152:155], v[72:87]
    ds_read_b64_tr_b16 v[168:169], v7 offset:24576
    ds_read_b64_tr_b16 v[170:171], v7 offset:25344
    ds_read_b64_tr_b16 v[172:173], v7 offset:27648
    ds_read_b64_tr_b16 v[174:175], v7 offset:28416
    ds_read_b64_tr_b16 v[176:177], v7 offset:30720
    ds_read_b64_tr_b16 v[178:179], v7 offset:31488
    ds_read_b64_tr_b16 v[180:181], v7 offset:33792
    v_mfma_f32_32x32x16_bf16 v[72:87], v[188:191], v[160:163], v[72:87]
    ds_read_b64_tr_b16 v[182:183], v7 offset:34560
    v_mul_f32 v40, v201, v40
    v_mul_f32 v41, v201, v41
    v_mul_f32 v42, v201, v42
    v_mul_f32 v43, v201, v43
    v_mul_f32 v44, v201, v44
    v_mul_f32 v45, v201, v45
    v_mfma_f32_32x32x16_bf16 v[72:87], v[192:195], v[136:139], v[72:87]
    v_mul_f32 v46, v201, v46
    v_mul_f32 v47, v201, v47
    v_mul_f32 v40, v40, v48
    v_mul_f32 v41, v41, v49
    v_mul_f32 v42, v42, v50
    v_mul_f32 v43, v43, v51
    v_mul_f32 v44, v44, v52
    v_mfma_f32_32x32x16_bf16 v[72:87], v[196:199], v[144:147], v[72:87]
    v_mul_f32 v45, v45, v53
    v_mul_f32 v46, v46, v54
    v_mul_f32 v47, v47, v55
    v_cvt_pk_bf16_f32 v48, v40, v41
    v_cvt_pk_bf16_f32 v49, v42, v43
    v_cvt_pk_bf16_f32 v50, v44, v45
    v_cvt_pk_bf16_f32 v51, v46, v47
    v_mfma_f32_32x32x16_bf16 v[88:103], v[184:187], v[156:159], v[88:103]
    buffer_store_dwordx4 v[48:51], v18, s[20:23], s28 offen sc1
    v_mul_f32 v56, v205, v56
    v_mul_f32 v57, v205, v57
    v_mul_f32 v58, v205, v58
    v_mul_f32 v59, v205, v59
    v_mul_f32 v60, v205, v60
    v_mul_f32 v61, v205, v61
    v_mfma_f32_32x32x16_bf16 v[88:103], v[188:191], v[164:167], v[88:103]
    v_mul_f32 v62, v205, v62
    v_mul_f32 v63, v205, v63
    v_mul_f32 v56, v56, v64
    v_mul_f32 v57, v57, v65
    v_mul_f32 v58, v58, v66
    v_mul_f32 v59, v59, v67
    v_mul_f32 v60, v60, v68
    v_mfma_f32_32x32x16_bf16 v[88:103], v[192:195], v[140:143], v[88:103]
    v_mul_f32 v61, v61, v69
    v_mul_f32 v62, v62, v70
    v_mul_f32 v63, v63, v71
    v_cvt_pk_bf16_f32 v64, v56, v57
    v_cvt_pk_bf16_f32 v65, v58, v59
    v_cvt_pk_bf16_f32 v66, v60, v61
    v_cvt_pk_bf16_f32 v67, v62, v63
    v_mfma_f32_32x32x16_bf16 v[88:103], v[196:199], v[148:151], v[88:103]
    buffer_store_dwordx4 v[64:67], v19, s[20:23], s28 offen sc1
    s_waitcnt lgkmcnt(0)
    ds_write_b32 v246, v245 offset:0
    v_mfma_f32_32x32x16_bf16 v[104:119], v[168:171], v[152:155], v[104:119]
    s_nop 5
    v_mul_f32 v72, v201, v72
    v_mul_f32 v73, v201, v73
    v_mul_f32 v74, v201, v74
    v_mul_f32 v75, v201, v75
    v_mul_f32 v76, v201, v76
    v_mfma_f32_32x32x16_bf16 v[104:119], v[172:175], v[160:163], v[104:119]
    v_mul_f32 v77, v201, v77
    v_mul_f32 v78, v201, v78
    v_mul_f32 v79, v201, v79
    v_mul_f32 v72, v72, v80
    v_mul_f32 v73, v73, v81
    v_mul_f32 v74, v74, v82
    v_mfma_f32_32x32x16_bf16 v[104:119], v[176:179], v[136:139], v[104:119]
    v_mul_f32 v75, v75, v83
    v_mul_f32 v76, v76, v84
    v_mul_f32 v77, v77, v85
    v_mul_f32 v78, v78, v86
    v_mul_f32 v79, v79, v87
    v_cvt_pk_bf16_f32 v80, v72, v73
    v_mfma_f32_32x32x16_bf16 v[104:119], v[180:183], v[144:147], v[104:119]
    v_cvt_pk_bf16_f32 v81, v74, v75
    v_cvt_pk_bf16_f32 v82, v76, v77
    v_cvt_pk_bf16_f32 v83, v78, v79
    buffer_store_dwordx4 v[80:83], v18, s[20:23], s29 offen sc1
    v_mul_f32 v88, v205, v88
    v_mul_f32 v89, v205, v89
    v_mfma_f32_32x32x16_bf16 v[120:135], v[168:171], v[156:159], v[120:135]
    v_mul_f32 v90, v205, v90
    v_mul_f32 v91, v205, v91
    v_mul_f32 v92, v205, v92
    v_mul_f32 v93, v205, v93
    v_mul_f32 v94, v205, v94
    v_mul_f32 v95, v205, v95
    v_mfma_f32_32x32x16_bf16 v[120:135], v[172:175], v[164:167], v[120:135]
    v_mul_f32 v88, v88, v96
    v_mul_f32 v89, v89, v97
    v_mul_f32 v90, v90, v98
    v_mul_f32 v91, v91, v99
    v_mul_f32 v92, v92, v100
    v_mul_f32 v93, v93, v101
    v_mfma_f32_32x32x16_bf16 v[120:135], v[176:179], v[140:143], v[120:135]
    v_mul_f32 v94, v94, v102
    v_mul_f32 v95, v95, v103
    v_cvt_pk_bf16_f32 v96, v88, v89
    v_cvt_pk_bf16_f32 v97, v90, v91
    v_cvt_pk_bf16_f32 v98, v92, v93
    v_cvt_pk_bf16_f32 v99, v94, v95
    v_mfma_f32_32x32x16_bf16 v[120:135], v[180:183], v[148:151], v[120:135]
    buffer_store_dwordx4 v[96:99], v19, s[20:23], s29 offen sc1
    v_mul_f32 v104, v201, v104
    v_mul_f32 v105, v201, v105
    v_mul_f32 v106, v201, v106
    v_mul_f32 v107, v201, v107
    v_mul_f32 v108, v201, v108
    v_mul_f32 v109, v201, v109
    v_mul_f32 v110, v201, v110
    v_mul_f32 v111, v201, v111
    v_mul_f32 v104, v104, v112
    v_mul_f32 v105, v105, v113
    v_mul_f32 v106, v106, v114
    v_mul_f32 v107, v107, v115
    v_mul_f32 v108, v108, v116
    v_mul_f32 v109, v109, v117
    v_mul_f32 v110, v110, v118
    v_mul_f32 v111, v111, v119
    v_cvt_pk_bf16_f32 v112, v104, v105
    v_cvt_pk_bf16_f32 v113, v106, v107
    v_cvt_pk_bf16_f32 v114, v108, v109
    v_cvt_pk_bf16_f32 v115, v110, v111
    buffer_store_dwordx4 v[112:115], v18, s[20:23], s30 offen sc1
    v_mul_f32 v120, v205, v120
    v_mul_f32 v121, v205, v121
    v_mul_f32 v122, v205, v122
    v_mul_f32 v123, v205, v123
    v_mul_f32 v124, v205, v124
    v_mul_f32 v125, v205, v125
    v_mul_f32 v126, v205, v126
    v_mul_f32 v127, v205, v127
    v_mul_f32 v120, v120, v128
    v_mul_f32 v121, v121, v129
    v_mul_f32 v122, v122, v130
    v_mul_f32 v123, v123, v131
    v_mul_f32 v124, v124, v132
    v_mul_f32 v125, v125, v133
    v_mul_f32 v126, v126, v134
    v_mul_f32 v127, v127, v135
    v_cvt_pk_bf16_f32 v128, v120, v121
    v_cvt_pk_bf16_f32 v129, v122, v123
    v_cvt_pk_bf16_f32 v130, v124, v125
    v_cvt_pk_bf16_f32 v131, v126, v127
    buffer_store_dwordx4 v[128:131], v19, s[20:23], s30 offen sc1
    s_branch L_hdone
L_two:
    ds_write_b32 v246, v245 offset:0
    v_mfma_f32_32x32x16_bf16 v[72:87], v[184:187], v[152:155], v[72:87]
    s_nop 6
    v_mul_f32 v40, v201, v40
    v_mul_f32 v41, v201, v41
    v_mul_f32 v42, v201, v42
    v_mul_f32 v43, v201, v43
    v_mul_f32 v44, v201, v44
    v_mfma_f32_32x32x16_bf16 v[72:87], v[188:191], v[160:163], v[72:87]
    v_mul_f32 v45, v201, v45
    v_mul_f32 v46, v201, v46
    v_mul_f32 v47, v201, v47
    v_mul_f32 v40, v40, v48
    v_mul_f32 v41, v41, v49
    v_mul_f32 v42, v42, v50
    v_mfma_f32_32x32x16_bf16 v[72:87], v[192:195], v[136:139], v[72:87]
    v_mul_f32 v43, v43, v51
    v_mul_f32 v44, v44, v52
    v_mul_f32 v45, v45, v53
    v_mul_f32 v46, v46, v54
    v_mul_f32 v47, v47, v55
    v_cvt_pk_bf16_f32 v48, v40, v41
    v_mfma_f32_32x32x16_bf16 v[72:87], v[196:199], v[144:147], v[72:87]
    v_cvt_pk_bf16_f32 v49, v42, v43
    v_cvt_pk_bf16_f32 v50, v44, v45
    v_cvt_pk_bf16_f32 v51, v46, v47
    buffer_store_dwordx4 v[48:51], v18, s[20:23], s28 offen sc1
    v_mul_f32 v56, v205, v56
    v_mul_f32 v57, v205, v57
    v_mfma_f32_32x32x16_bf16 v[88:103], v[184:187], v[156:159], v[88:103]
    v_mul_f32 v58, v205, v58
    v_mul_f32 v59, v205, v59
    v_mul_f32 v60, v205, v60
    v_mul_f32 v61, v205, v61
    v_mul_f32 v62, v205, v62
    v_mul_f32 v63, v205, v63
    v_mfma_f32_32x32x16_bf16 v[88:103], v[188:191], v[164:167], v[88:103]
    v_mul_f32 v56, v56, v64
    v_mul_f32 v57, v57, v65
    v_mul_f32 v58, v58, v66
    v_mul_f32 v59, v59, v67
    v_mul_f32 v60, v60, v68
    v_mul_f32 v61, v61, v69
    v_mfma_f32_32x32x16_bf16 v[88:103], v[192:195], v[140:143], v[88:103]
    v_mul_f32 v62, v62, v70
    v_mul_f32 v63, v63, v71
    v_cvt_pk_bf16_f32 v64, v56, v57
    v_cvt_pk_bf16_f32 v65, v58, v59
    v_cvt_pk_bf16_f32 v66, v60, v61
    v_cvt_pk_bf16_f32 v67, v62, v63
    v_mfma_f32_32x32x16_bf16 v[88:103], v[196:199], v[148:151], v[88:103]
    buffer_store_dwordx4 v[64:67], v19, s[20:23], s28 offen sc1
    v_mul_f32 v72, v201, v72
    v_mul_f32 v73, v201, v73
    v_mul_f32 v74, v201, v74
    v_mul_f32 v75, v201, v75
    v_mul_f32 v76, v201, v76
    v_mul_f32 v77, v201, v77
    v_mul_f32 v78, v201, v78
    v_mul_f32 v79, v201, v79
    v_mul_f32 v72, v72, v80
    v_mul_f32 v73, v73, v81
    v_mul_f32 v74, v74, v82
    v_mul_f32 v75, v75, v83
    v_mul_f32 v76, v76, v84
    v_mul_f32 v77, v77, v85
    v_mul_f32 v78, v78, v86
    v_mul_f32 v79, v79, v87
    v_cvt_pk_bf16_f32 v80, v72, v73
    v_cvt_pk_bf16_f32 v81, v74, v75
    v_cvt_pk_bf16_f32 v82, v76, v77
    v_cvt_pk_bf16_f32 v83, v78, v79
    buffer_store_dwordx4 v[80:83], v18, s[20:23], s29 offen sc1
    v_mul_f32 v88, v205, v88
    v_mul_f32 v89, v205, v89
    v_mul_f32 v90, v205, v90
    v_mul_f32 v91, v205, v91
    v_mul_f32 v92, v205, v92
    v_mul_f32 v93, v205, v93
    v_mul_f32 v94, v205, v94
    v_mul_f32 v95, v205, v95
    v_mul_f32 v88, v88, v96
    v_mul_f32 v89, v89, v97
    v_mul_f32 v90, v90, v98
    v_mul_f32 v91, v91, v99
    v_mul_f32 v92, v92, v100
    v_mul_f32 v93, v93, v101
    v_mul_f32 v94, v94, v102
    v_mul_f32 v95, v95, v103
    v_cvt_pk_bf16_f32 v96, v88, v89
    v_cvt_pk_bf16_f32 v97, v90, v91
    v_cvt_pk_bf16_f32 v98, v92, v93
    v_cvt_pk_bf16_f32 v99, v94, v95
    buffer_store_dwordx4 v[96:99], v19, s[20:23], s29 offen sc1
L_hdone:
    ds_write_b32 v246, v245 offset:160
    v_lshrrev_b32 v10, 5, v0
    v_bfe_u32 v11, v0, 2, 2
    v_lshl_add_u32 v12, v10, 3, v11
    v_lshlrev_b32 v12, 7, v12
    v_lshrrev_b32 v11, 1, v11
    v_xor_b32 v11, s54, v11
    v_lshl_add_u32 v12, v11, 6, v12
    v_and_b32 v11, 1, v0
    v_lshl_add_u32 v12, v11, 5, v12
    v_bfe_u32 v11, v0, 4, 1
    v_lshl_add_u32 v12, v11, 4, v12
    v_bfe_u32 v11, v0, 1, 1
    v_lshl_add_u32 v12, v11, 3, v12
    s_lshl_b32 s44, s54, 11
    v_add_u32 v1, s44, v12
    v_xor_b32 v2, 64, v1
    v_add_u32 v3, 65536, v1
    v_add_u32 v4, 65536, v2
    v_and_b32 v9, 31, v0
    v_lshlrev_b32 v9, 16, v9
    v_lshl_add_u32 v9, v10, 5, v9
    s_lshl_b32 s44, s53, 5
    s_add_u32 s44, s44, s51
    s_lshl_b32 s44, s44, 10
    s_lshl_b32 s45, s52, 7
    s_add_u32 s44, s44, s45
    s_lshl_b32 s45, s54, 6
    s_add_u32 s44, s44, s45
    v_add_u32 v9, s44, v9
    s_lshl_b32 s48, s56, 2
    s_lshl_b32 s44, s55, 1
    s_add_u32 s48, s48, s44
    s_add_u32 s48, s48, s53
    s_mul_i32 s48, s48, 86
    s_mul_i32 s44, s54, 43
    s_add_u32 s48, s48, s44
    s_add_u32 s48, s48, 47
    s_sub_u32 s48, s48, s61
    s_lshl_b32 s48, s48, 10
    s_sub_u32 s32, s48, 44032
    v_lshlrev_b32 v8, 4, v0
    s_lshl_b32 s44, s54, 4
    v_add_u32 v10, s44, v0
    v_min_u32 v10, 31, v10
    v_lshlrev_b32 v10, 7, v10
    s_lshl_b32 s46, s56, 1
    s_add_u32 s46, s46, s55
    s_lshl_b32 s46, s46, 12
    s_add_u32 s46, s46, 8388608
    v_mov_b32 v200, 163360
    s_mov_b32 s50, 1048576
    s_branch L_h_first
L_h:
    s_sleep 1
L_h_first:
    ds_read_b128 v[192:195], v200
    s_sub_u32 s50, s50, 1
    s_cbranch_scc1 L_h_out
    s_waitcnt lgkmcnt(0)
    v_and_b32 v192, v192, v193
    v_and_b32 v194, v194, v195
    v_and_b32 v192, v192, v194
    v_cmp_eq_u32 s[62:63], 0, v192
    s_cmp_lg_u64 s[62:63], 0
    s_cbranch_scc1 L_h
L_h_out:
    s_waitcnt lgkmcnt(0)
    ds_read_b64_tr_b16 v[72:73], v1 offset:32768
    ds_read_b64_tr_b16 v[74:75], v1 offset:33280
    ds_read_b64_tr_b16 v[76:77], v2 offset:32768
    ds_read_b64_tr_b16 v[78:79], v2 offset:33280
    ds_read_b64_tr_b16 v[80:81], v1 offset:36864
    ds_read_b64_tr_b16 v[82:83], v1 offset:37376
    ds_read_b64_tr_b16 v[84:85], v2 offset:36864
    ds_read_b64_tr_b16 v[86:87], v2 offset:37376
    s_waitcnt lgkmcnt(4)
    ds_read_b64_tr_b16 v[88:89], v1 offset:40960
    ds_read_b64_tr_b16 v[90:91], v1 offset:41472
    ds_read_b64_tr_b16 v[92:93], v2 offset:40960
    ds_read_b64_tr_b16 v[94:95], v2 offset:41472
    ds_read_b64_tr_b16 v[96:97], v1 offset:45056
    ds_read_b64_tr_b16 v[98:99], v1 offset:45568
    ds_read_b64_tr_b16 v[100:101], v2 offset:45056
    ds_read_b64_tr_b16 v[102:103], v2 offset:45568
    s_waitcnt lgkmcnt(4)
    ds_read_b64_tr_b16 v[104:105], v3 offset:32768
    ds_read_b64_tr_b16 v[106:107], v3 offset:33280
    ds_read_b64_tr_b16 v[108:109], v4 offset:32768
    ds_read_b64_tr_b16 v[110:111], v4 offset:33280
    ds_read_b64_tr_b16 v[112:113], v3 offset:36864
    ds_read_b64_tr_b16 v[114:115], v3 offset:37376
    ds_read_b64_tr_b16 v[116:117], v4 offset:36864
    ds_read_b64_tr_b16 v[118:119], v4 offset:37376
    s_waitcnt lgkmcnt(4)
    ds_read_b64_tr_b16 v[120:121], v3 offset:40960
    ds_read_b64_tr_b16 v[122:123], v3 offset:41472
    ds_read_b64_tr_b16 v[124:125], v4 offset:40960
    ds_read_b64_tr_b16 v[126:127], v4 offset:41472
    ds_read_b64_tr_b16 v[128:129], v3 offset:45056
    ds_read_b64_tr_b16 v[130:131], v3 offset:45568
    ds_read_b64_tr_b16 v[132:133], v4 offset:45056
    ds_read_b64_tr_b16 v[134:135], v4 offset:45568
    s_waitcnt lgkmcnt(4)
    ds_read_b64_tr_b16 v[136:137], v3 offset:49152
    ds_read_b64_tr_b16 v[138:139], v3 offset:49664
    ds_read_b64_tr_b16 v[140:141], v4 offset:49152
    ds_read_b64_tr_b16 v[142:143], v4 offset:49664
    ds_read_b64_tr_b16 v[144:145], v3 offset:53248
    ds_read_b64_tr_b16 v[146:147], v3 offset:53760
    ds_read_b64_tr_b16 v[148:149], v4 offset:53248
    ds_read_b64_tr_b16 v[150:151], v4 offset:53760
    s_waitcnt lgkmcnt(4)
    ds_read_b64_tr_b16 v[152:153], v1 offset:0
    ds_read_b64_tr_b16 v[154:155], v1 offset:512
    ds_read_b64_tr_b16 v[156:157], v2 offset:0
    ds_read_b64_tr_b16 v[158:159], v2 offset:512
    ds_read_b64_tr_b16 v[160:161], v1 offset:4096
    ds_read_b64_tr_b16 v[162:163], v1 offset:4608
    ds_read_b64_tr_b16 v[164:165], v2 offset:4096
    ds_read_b64_tr_b16 v[166:167], v2 offset:4608
    s_waitcnt lgkmcnt(4)
    ds_read_b64_tr_b16 v[168:169], v1 offset:8192
    ds_read_b64_tr_b16 v[170:171], v1 offset:8704
    ds_read_b64_tr_b16 v[172:173], v2 offset:8192
    ds_read_b64_tr_b16 v[174:175], v2 offset:8704
    ds_read_b64_tr_b16 v[176:177], v1 offset:12288
    ds_read_b64_tr_b16 v[178:179], v1 offset:12800
    ds_read_b64_tr_b16 v[180:181], v2 offset:12288
    ds_read_b64_tr_b16 v[182:183], v2 offset:12800
    s_waitcnt lgkmcnt(4)
    ds_read_b64_tr_b16 v[184:185], v1 offset:49152
    ds_read_b64_tr_b16 v[186:187], v1 offset:49664
    ds_read_b64_tr_b16 v[188:189], v2 offset:49152
    ds_read_b64_tr_b16 v[190:191], v2 offset:49664
    s_waitcnt lgkmcnt(0)
    ds_write_b32 v246, v245 offset:64
    v_mov_b32 v200, 163392
    s_mov_b32 s50, 1048576
L_cco:
    ds_read_b128 v[192:195], v200
    s_sub_u32 s50, s50, 1
    s_cbranch_scc1 L_cco_out
    s_waitcnt lgkmcnt(0)
    v_and_b32 v192, v192, v193
    v_and_b32 v194, v194, v195
    v_and_b32 v192, v192, v194
    v_cmp_eq_u32 s[62:63], 0, v192
    s_cmp_lg_u64 s[62:63], 0
    s_cbranch_scc1 L_cco
L_cco_out:
    s_waitcnt lgkmcnt(0)
    s_waitcnt vmcnt(0)
    v_mov_b32 v192, s49
    v_mov_b32 v193, 0
    s_mov_b64 exec, 1
    buffer_store_dword v192, v193, s[20:23], s60 offen sc1
    s_mov_b64 exec, -1
    s_cmp_gt_u32 s61, 28
    s_cselect_b32 s40, s58, s3
    s_add_u32 m0, s57, 32768
    s_add_u32 s40, s40, 458752
    buffer_load_dwordx4 v244, s[16:19], s40 offen lds
    s_cmp_gt_u32 s61, 29
    s_cselect_b32 s40, s58, s3
    s_add_u32 m0, s57, 36864
    s_add_u32 s40, s40, 475136
    buffer_load_dwordx4 v244, s[16:19], s40 offen lds
    s_cmp_gt_u32 s61, 30
    s_cselect_b32 s40, s58, s3
    s_add_u32 m0, s57, 40960
    s_add_u32 s40, s40, 491520
    buffer_load_dwordx4 v244, s[16:19], s40 offen lds
    s_cmp_gt_u32 s61, 31
    s_cselect_b32 s40, s58, s3
    s_add_u32 m0, s57, 45056
    s_add_u32 s40, s40, 507904
    buffer_load_dwordx4 v244, s[16:19], s40 offen lds
    s_cmp_gt_u32 s61, 32
    s_cselect_b32 s40, s58, s3
    s_add_u32 m0, s57, 98304
    s_add_u32 s40, s40, 524288
    buffer_load_dwordx4 v244, s[16:19], s40 offen lds
    s_cmp_gt_u32 s61, 33
    s_cselect_b32 s40, s58, s3
    s_add_u32 m0, s57, 102400
    s_add_u32 s40, s40, 540672
    buffer_load_dwordx4 v244, s[16:19], s40 offen lds
    s_cmp_gt_u32 s61, 34
    s_cselect_b32 s40, s58, s3
    s_add_u32 m0, s57, 106496
    s_add_u32 s40, s40, 557056
    buffer_load_dwordx4 v244, s[16:19], s40 offen lds
    s_cmp_gt_u32 s61, 35
    s_cselect_b32 s40, s58, s3
    s_add_u32 m0, s57, 110592
    s_add_u32 s40, s40, 573440
    buffer_load_dwordx4 v244, s[16:19], s40 offen lds
    s_cmp_gt_u32 s61, 36
    s_cselect_b32 s40, s58, s3
    s_add_u32 m0, s57, 114688
    s_add_u32 s40, s40, 589824
    buffer_load_dwordx4 v244, s[16:19], s40 offen lds
    s_cmp_gt_u32 s61, 37
    s_cselect_b32 s40, s58, s3
    s_add_u32 m0, s57, 118784
    s_add_u32 s40, s40, 606208
    buffer_load_dwordx4 v244, s[16:19], s40 offen lds
    s_cmp_gt_u32 s61, 38
    s_cselect_b32 s40, s58, s3
    s_add_u32 m0, s57, 0
    s_add_u32 s40, s40, 622592
    buffer_load_dwordx4 v244, s[16:19], s40 offen lds
    s_cmp_gt_u32 s61, 39
    s_cselect_b32 s40, s58, s3
    s_add_u32 m0, s57, 4096
    s_add_u32 s40, s40, 638976
    buffer_load_dwordx4 v244, s[16:19], s40 offen lds
    s_cmp_gt_u32 s61, 40
    s_cselect_b32 s40, s58, s3
    s_add_u32 m0, s57, 8192
    s_add_u32 s40, s40, 655360
    buffer_load_dwordx4 v244, s[16:19], s40 offen lds
    s_cmp_gt_u32 s61, 41
    s_cselect_b32 s40, s58, s3
    s_add_u32 m0, s57, 12288
    s_add_u32 s40, s40, 671744
    buffer_load_dwordx4 v244, s[16:19], s40 offen lds
    s_cmp_gt_u32 s61, 42
    s_cselect_b32 s40, s58, s3
    s_add_u32 m0, s57, 49152
    s_add_u32 s40, s40, 688128
    buffer_load_dwordx4 v244, s[16:19], s40 offen lds
    s_mov_b32 s50, 1048576
    s_mov_b64 exec, 0x1ffff
L_hpoll:
    buffer_load_dword v11, v10, s[20:23], s46 offen sc1
    s_sub_u32 s50, s50, 1
    s_cbranch_scc1 L_hpoll_out
    s_waitcnt vmcnt(0)
    v_cmp_ne_u32 vcc, s49, v11
    s_cbranch_vccnz L_hpoll
L_hpoll_out:
    s_mov_b64 exec, -1
    s_waitcnt vmcnt(0)
    s_cmp_gt_u32 s61, 0
    s_cselect_b32 s40, s48, s32
    buffer_load_dwordx4 v[192:195], v8, s[20:23], s40 offen
    s_cmp_gt_u32 s61, 1
    s_cselect_b32 s40, s48, s32
    buffer_load_dwordx4 v[196:199], v8, s[20:23], s40 offen offset:1024
    s_cmp_gt_u32 s61, 2
    s_cselect_b32 s40, s48, s32
    buffer_load_dwordx4 v[200:203], v8, s[20:23], s40 offen offset:2048
    s_cmp_gt_u32 s61, 3
    s_cselect_b32 s40, s48, s32
    buffer_load_dwordx4 v[204:207], v8, s[20:23], s40 offen offset:3072
    s_add_u32 s48, s48, 4096
    s_add_u32 s32, s32, 4096
    s_cmp_gt_u32 s61, 4
    s_cselect_b32 s40, s48, s32
    buffer_load_dwordx4 v[208:211], v8, s[20:23], s40 offen
    s_cmp_gt_u32 s61, 5
    s_cselect_b32 s40, s48, s32
    buffer_load_dwordx4 v[212:215], v8, s[20:23], s40 offen offset:1024
    s_cmp_gt_u32 s61, 6
    s_cselect_b32 s40, s48, s32
    buffer_load_dwordx4 v[216:219], v8, s[20:23], s40 offen offset:2048
    s_cmp_gt_u32 s61, 7
    s_cselect_b32 s40, s48, s32
    buffer_load_dwordx4 v[220:223], v8, s[20:23], s40 offen offset:3072
    v_mov_b32 v252, 163408
    s_waitcnt vmcnt(7) lgkmcnt(0)
    ds_write_b32 v246, v245 offset:144
    v_mfma_f32_32x32x16_bf16 v[16:31], v[72:75], v[192:195], 0
    v_mfma_f32_32x32x16_bf16 v[32:47], v[76:79], v[192:195], 0
    s_add_u32 s48, s48, 4096
    s_add_u32 s32, s32, 4096
    s_cmp_gt_u32 s61, 8
    s_cselect_b32 s40, s48, s32
    buffer_load_dwordx4 v[224:227], v8, s[20:23], s40 offen
    s_waitcnt vmcnt(7) lgkmcnt(0)
    v_mfma_f32_32x32x16_bf16 v[16:31], v[80:83], v[196:199], v[16:31]
    v_mfma_f32_32x32x16_bf16 v[32:47], v[84:87], v[196:199], v[32:47]
    s_cmp_gt_u32 s61, 9
    s_cselect_b32 s40, s48, s32
    buffer_load_dwordx4 v[228:231], v8, s[20:23], s40 offen offset:1024
    s_waitcnt vmcnt(7) lgkmcnt(0)
    v_mfma_f32_32x32x16_bf16 v[16:31], v[88:91], v[200:203], v[16:31]
    v_mfma_f32_32x32x16_bf16 v[32:47], v[92:95], v[200:203], v[32:47]
    s_cmp_gt_u32 s61, 10
    s_cselect_b32 s40, s48, s32
    buffer_load_dwordx4 v[232:235], v8, s[20:23], s40 offen offset:2048
    s_waitcnt vmcnt(7) lgkmcnt(0)
    v_mfma_f32_32x32x16_bf16 v[16:31], v[96:99], v[204:207], v[16:31]
    v_mfma_f32_32x32x16_bf16 v[32:47], v[100:103], v[204:207], v[32:47]
    s_cmp_gt_u32 s61, 11
    s_cselect_b32 s40, s48, s32
    buffer_load_dwordx4 v[236:239], v8, s[20:23], s40 offen offset:3072
    s_waitcnt vmcnt(7) lgkmcnt(0)
    v_mfma_f32_32x32x16_bf16 v[16:31], v[104:107], v[208:211], v[16:31]
    v_mfma_f32_32x32x16_bf16 v[32:47], v[108:111], v[208:211], v[32:47]
    s_add_u32 s48, s48, 4096
    s_add_u32 s32, s32, 4096
    s_cmp_gt_u32 s61, 12
    s_cselect_b32 s40, s48, s32
    buffer_load_dwordx4 v[192:195], v8, s[20:23], s40 offen
    s_waitcnt vmcnt(7) lgkmcnt(0)
    v_mfma_f32_32x32x16_bf16 v[16:31], v[112:115], v[212:215], v[16:31]
    v_mfma_f32_32x32x16_bf16 v[32:47], v[116:119], v[212:215], v[32:47]
    s_cmp_gt_u32 s61, 13
    s_cselect_b32 s40, s48, s32
    buffer_load_dwordx4 v[196:199], v8, s[20:23], s40 offen offset:1024
    s_waitcnt vmcnt(7) lgkmcnt(0)
    v_mfma_f32_32x32x16_bf16 v[16:31], v[120:123], v[216:219], v[16:31]
    v_mfma_f32_32x32x16_bf16 v[32:47], v[124:127], v[216:219], v[32:47]
    s_cmp_gt_u32 s61, 14
    s_cselect_b32 s40, s48, s32
    buffer_load_dwordx4 v[200:203], v8, s[20:23], s40 offen offset:2048
    s_waitcnt vmcnt(7) lgkmcnt(0)
    v_mfma_f32_32x32x16_bf16 v[16:31], v[128:131], v[220:223], v[16:31]
    v_mfma_f32_32x32x16_bf16 v[32:47], v[132:135], v[220:223], v[32:47]
    s_cmp_gt_u32 s61, 15
    s_cselect_b32 s40, s48, s32
    buffer_load_dwordx4 v[204:207], v8, s[20:23], s40 offen offset:3072
    s_waitcnt vmcnt(7) lgkmcnt(0)
    v_mfma_f32_32x32x16_bf16 v[16:31], v[136:139], v[224:227], v[16:31]
    v_mfma_f32_32x32x16_bf16 v[32:47], v[140:143], v[224:227], v[32:47]
    s_add_u32 s48, s48, 4096
    s_add_u32 s32, s32, 4096
    s_cmp_gt_u32 s61, 16
    s_cselect_b32 s40, s48, s32
    buffer_load_dwordx4 v[208:211], v8, s[20:23], s40 offen
    s_waitcnt vmcnt(7) lgkmcnt(0)
    v_mfma_f32_32x32x16_bf16 v[16:31], v[144:147], v[228:231], v[16:31]
    v_mfma_f32_32x32x16_bf16 v[32:47], v[148:151], v[228:231], v[32:47]
    s_cmp_gt_u32 s61, 17
    s_cselect_b32 s40, s48, s32
    buffer_load_dwordx4 v[212:215], v8, s[20:23], s40 offen offset:1024
    s_waitcnt vmcnt(7) lgkmcnt(0)
    v_mfma_f32_32x32x16_bf16 v[16:31], v[152:155], v[232:235], v[16:31]
    v_mfma_f32_32x32x16_bf16 v[32:47], v[156:159], v[232:235], v[32:47]
    s_cmp_gt_u32 s61, 18
    s_cselect_b32 s40, s48, s32
    buffer_load_dwordx4 v[216:219], v8, s[20:23], s40 offen offset:2048
    s_waitcnt vmcnt(7) lgkmcnt(0)
    v_mfma_f32_32x32x16_bf16 v[16:31], v[160:163], v[236:239], v[16:31]
    v_mfma_f32_32x32x16_bf16 v[32:47], v[164:167], v[236:239], v[32:47]
    s_cmp_gt_u32 s61, 19
    s_cselect_b32 s40, s48, s32
    buffer_load_dwordx4 v[220:223], v8, s[20:23], s40 offen offset:3072
    s_waitcnt vmcnt(7) lgkmcnt(0)
    v_mfma_f32_32x32x16_bf16 v[16:31], v[168:171], v[192:195], v[16:31]
    v_mfma_f32_32x32x16_bf16 v[32:47], v[172:175], v[192:195], v[32:47]
    s_add_u32 s48, s48, 4096
    s_add_u32 s32, s32, 4096
    s_cmp_gt_u32 s61, 20
    s_cselect_b32 s40, s48, s32
    buffer_load_dwordx4 v[224:227], v8, s[20:23], s40 offen
    s_waitcnt vmcnt(7) lgkmcnt(0)
    v_mfma_f32_32x32x16_bf16 v[16:31], v[176:179], v[196:199], v[16:31]
    ds_read_b64_tr_b16 v[72:73], v1 offset:53248
    ds_read_b64_tr_b16 v[74:75], v1 offset:53760
    v_mfma_f32_32x32x16_bf16 v[32:47], v[180:183], v[196:199], v[32:47]
    ds_read_b64_tr_b16 v[76:77], v2 offset:53248
    ds_read_b64_tr_b16 v[78:79], v2 offset:53760
    s_cmp_gt_u32 s61, 21
    s_cselect_b32 s40, s48, s32
    buffer_load_dwordx4 v[228:231], v8, s[20:23], s40 offen offset:1024
    s_waitcnt vmcnt(7) lgkmcnt(4)
    v_mfma_f32_32x32x16_bf16 v[16:31], v[184:187], v[200:203], v[16:31]
    ds_read_b64_tr_b16 v[80:81], v1 offset:57344
    ds_read_b64_tr_b16 v[82:83], v1 offset:57856
    v_mfma_f32_32x32x16_bf16 v[32:47], v[188:191], v[200:203], v[32:47]
    ds_read_b64_tr_b16 v[84:85], v2 offset:57344
    ds_read_b64_tr_b16 v[86:87], v2 offset:57856
    s_cmp_gt_u32 s61, 22
    s_cselect_b32 s40, s48, s32
    buffer_load_dwordx4 v[232:235], v8, s[20:23], s40 offen offset:2048
    s_waitcnt vmcnt(7) lgkmcnt(4)
    v_mfma_f32_32x32x16_bf16 v[16:31], v[72:75], v[204:207], v[16:31]
    ds_read_b64_tr_b16 v[88:89], v1 offset:61440
    ds_read_b64_tr_b16 v[90:91], v1 offset:61952
    v_mfma_f32_32x32x16_bf16 v[32:47], v[76:79], v[204:207], v[32:47]
    ds_read_b64_tr_b16 v[92:93], v2 offset:61440
    ds_read_b64_tr_b16 v[94:95], v2 offset:61952
    s_cmp_gt_u32 s61, 23
    s_cselect_b32 s40, s48, s32
    buffer_load_dwordx4 v[236:239], v8, s[20:23], s40 offen offset:3072
    s_waitcnt vmcnt(7) lgkmcnt(4)
    v_mfma_f32_32x32x16_bf16 v[16:31], v[80:83], v[208:211], v[16:31]
    ds_read_b64_tr_b16 v[96:97], v3 offset:0
    ds_read_b64_tr_b16 v[98:99], v3 offset:512
    v_mfma_f32_32x32x16_bf16 v[32:47], v[84:87], v[208:211], v[32:47]
    ds_read_b64_tr_b16 v[100:101], v4 offset:0
    ds_read_b64_tr_b16 v[102:103], v4 offset:512
    s_add_u32 s48, s48, 4096
    s_add_u32 s32, s32, 4096
    s_cmp_gt_u32 s61, 24
    s_cselect_b32 s40, s48, s32
    buffer_load_dwordx4 v[192:195], v8, s[20:23], s40 offen
    s_waitcnt vmcnt(7) lgkmcnt(4)
    v_mfma_f32_32x32x16_bf16 v[16:31], v[88:91], v[212:215], v[16:31]
    ds_read_b64_tr_b16 v[72:73], v3 offset:4096
    ds_read_b64_tr_b16 v[74:75], v3 offset:4608
    v_mfma_f32_32x32x16_bf16 v[32:47], v[92:95], v[212:215], v[32:47]
    ds_read_b64_tr_b16 v[76:77], v4 offset:4096
    ds_read_b64_tr_b16 v[78:79], v4 offset:4608
    ds_read_b128 v[248:251], v252 offset:0
    s_cmp_gt_u32 s61, 25
    s_cselect_b32 s40, s48, s32
    buffer_load_dwordx4 v[196:199], v8, s[20:23], s40 offen offset:1024
    s_waitcnt vmcnt(7) lgkmcnt(0)
    v_and_b32 v248, v248, v249
    v_and_b32 v250, v250, v251
    v_and_b32 v248, v248, v250
    v_cmp_eq_u32 vcc, 0, v248
    s_cbranch_vccz L_r18_out
    s_mov_b32 s50, 1048576
L_r18:
    ds_read_b128 v[248:251], v252 offset:0
    s_sub_u32 s50, s50, 1
    s_cbranch_scc1 L_r18_out
    s_waitcnt lgkmcnt(0)
    v_and_b32 v248, v248, v249
    v_and_b32 v250, v250, v251
    v_and_b32 v248, v248, v250
    v_cmp_eq_u32 vcc, 0, v248
    s_cbranch_vccnz L_r18
L_r18_out:
    v_mfma_f32_32x32x16_bf16 v[16:31], v[96:99], v[216:219], v[16:31]
    ds_read_b64_tr_b16 v[80:81], v1 offset:24576
    ds_read_b64_tr_b16 v[82:83], v1 offset:25088
    v_mfma_f32_32x32x16_bf16 v[32:47], v[100:103], v[216:219], v[32:47]
    ds_read_b64_tr_b16 v[84:85], v2 offset:24576
    ds_read_b64_tr_b16 v[86:87], v2 offset:25088
    s_cmp_gt_u32 s61, 26
    s_cselect_b32 s40, s48, s32
    buffer_load_dwordx4 v[200:203], v8, s[20:23], s40 offen offset:2048
    s_waitcnt vmcnt(7) lgkmcnt(4)
    v_mfma_f32_32x32x16_bf16 v[16:31], v[72:75], v[220:223], v[16:31]
    ds_read_b64_tr_b16 v[88:89], v1 offset:28672
    ds_read_b64_tr_b16 v[90:91], v1 offset:29184
    v_mfma_f32_32x32x16_bf16 v[32:47], v[76:79], v[220:223], v[32:47]
    ds_read_b64_tr_b16 v[92:93], v2 offset:28672
    ds_read_b64_tr_b16 v[94:95], v2 offset:29184
    s_cmp_gt_u32 s61, 27
    s_cselect_b32 s40, s48, s32
    buffer_load_dwordx4 v[204:207], v8, s[20:23], s40 offen offset:3072
    s_waitcnt vmcnt(7) lgkmcnt(4)
    v_mfma_f32_32x32x16_bf16 v[16:31], v[80:83], v[224:227], v[16:31]
    ds_read_b64_tr_b16 v[96:97], v3 offset:8192
    ds_read_b64_tr_b16 v[98:99], v3 offset:8704
    v_mfma_f32_32x32x16_bf16 v[32:47], v[84:87], v[224:227], v[32:47]
    ds_read_b64_tr_b16 v[100:101], v4 offset:8192
    ds_read_b64_tr_b16 v[102:103], v4 offset:8704
    s_add_u32 s48, s48, 4096
    s_add_u32 s32, s32, 4096
    s_cmp_gt_u32 s61, 28
    s_cselect_b32 s40, s48, s32
    buffer_load_dwordx4 v[208:211], v8, s[20:23], s40 offen
    s_waitcnt vmcnt(7) lgkmcnt(4)
    v_mfma_f32_32x32x16_bf16 v[16:31], v[88:91], v[228:231], v[16:31]
    ds_read_b64_tr_b16 v[72:73], v3 offset:12288
    ds_read_b64_tr_b16 v[74:75], v3 offset:12800
    v_mfma_f32_32x32x16_bf16 v[32:47], v[92:95], v[228:231], v[32:47]
    ds_read_b64_tr_b16 v[76:77], v4 offset:12288
    ds_read_b64_tr_b16 v[78:79], v4 offset:12800
    s_cmp_gt_u32 s61, 29
    s_cselect_b32 s40, s48, s32
    buffer_load_dwordx4 v[212:215], v8, s[20:23], s40 offen offset:1024
    s_waitcnt vmcnt(7) lgkmcnt(4)
    v_mfma_f32_32x32x16_bf16 v[16:31], v[96:99], v[232:235], v[16:31]
    ds_read_b64_tr_b16 v[80:81], v3 offset:16384
    ds_read_b64_tr_b16 v[82:83], v3 offset:16896
    v_mfma_f32_32x32x16_bf16 v[32:47], v[100:103], v[232:235], v[32:47]
    ds_read_b64_tr_b16 v[84:85], v4 offset:16384
    ds_read_b64_tr_b16 v[86:87], v4 offset:16896
    s_cmp_gt_u32 s61, 30
    s_cselect_b32 s40, s48, s32
    buffer_load_dwordx4 v[216:219], v8, s[20:23], s40 offen offset:2048
    s_waitcnt vmcnt(7) lgkmcnt(4)
    v_mfma_f32_32x32x16_bf16 v[16:31], v[72:75], v[236:239], v[16:31]
    ds_read_b64_tr_b16 v[88:89], v3 offset:20480
    ds_read_b64_tr_b16 v[90:91], v3 offset:20992
    v_mfma_f32_32x32x16_bf16 v[32:47], v[76:79], v[236:239], v[32:47]
    ds_read_b64_tr_b16 v[92:93], v4 offset:20480
    ds_read_b64_tr_b16 v[94:95], v4 offset:20992
    s_cmp_gt_u32 s61, 31
    s_cselect_b32 s40, s48, s32
    buffer_load_dwordx4 v[220:223], v8, s[20:23], s40 offen offset:3072
    s_waitcnt vmcnt(7) lgkmcnt(4)
    v_mfma_f32_32x32x16_bf16 v[16:31], v[80:83], v[192:195], v[16:31]
    ds_read_b64_tr_b16 v[96:97], v3 offset:24576
    ds_read_b64_tr_b16 v[98:99], v3 offset:25088
    v_mfma_f32_32x32x16_bf16 v[32:47], v[84:87], v[192:195], v[32:47]
    ds_read_b64_tr_b16 v[100:101], v4 offset:24576
    ds_read_b64_tr_b16 v[102:103], v4 offset:25088
    s_add_u32 s48, s48, 4096
    s_add_u32 s32, s32, 4096
    s_cmp_gt_u32 s61, 32
    s_cselect_b32 s40, s48, s32
    buffer_load_dwordx4 v[224:227], v8, s[20:23], s40 offen
    s_waitcnt vmcnt(7) lgkmcnt(4)
    v_mfma_f32_32x32x16_bf16 v[16:31], v[88:91], v[196:199], v[16:31]
    ds_read_b64_tr_b16 v[72:73], v3 offset:28672
    ds_read_b64_tr_b16 v[74:75], v3 offset:29184
    v_mfma_f32_32x32x16_bf16 v[32:47], v[92:95], v[196:199], v[32:47]
    ds_read_b64_tr_b16 v[76:77], v4 offset:28672
    ds_read_b64_tr_b16 v[78:79], v4 offset:29184
    ds_read_b128 v[248:251], v252 offset:64
    s_cmp_gt_u32 s61, 33
    s_cselect_b32 s40, s48, s32
    buffer_load_dwordx4 v[228:231], v8, s[20:23], s40 offen offset:1024
    s_waitcnt vmcnt(7) lgkmcnt(0)
    ds_write_b32 v246, v245 offset:112
    v_and_b32 v248, v248, v249
    v_and_b32 v250, v250, v251
    v_and_b32 v248, v248, v250
    v_cmp_eq_u32 vcc, 0, v248
    s_cbranch_vccz L_r26_out
    s_mov_b32 s50, 1048576
L_r26:
    ds_read_b128 v[248:251], v252 offset:64
    s_sub_u32 s50, s50, 1
    s_cbranch_scc1 L_r26_out
    s_waitcnt lgkmcnt(0)
    v_and_b32 v248, v248, v249
    v_and_b32 v250, v250, v251
    v_and_b32 v248, v248, v250
    v_cmp_eq_u32 vcc, 0, v248
    s_cbranch_vccnz L_r26
L_r26_out:
    v_mfma_f32_32x32x16_bf16 v[16:31], v[96:99], v[200:203], v[16:31]
    ds_read_b64_tr_b16 v[80:81], v1 offset:32768
    ds_read_b64_tr_b16 v[82:83], v1 offset:33280
    v_mfma_f32_32x32x16_bf16 v[32:47], v[100:103], v[200:203], v[32:47]
    ds_read_b64_tr_b16 v[84:85], v2 offset:32768
    ds_read_b64_tr_b16 v[86:87], v2 offset:33280
    s_cmp_gt_u32 s61, 34
    s_cselect_b32 s40, s48, s32
    buffer_load_dwordx4 v[232:235], v8, s[20:23], s40 offen offset:2048
    s_waitcnt vmcnt(7) lgkmcnt(4)
    v_mfma_f32_32x32x16_bf16 v[16:31], v[72:75], v[204:207], v[16:31]
    ds_read_b64_tr_b16 v[88:89], v1 offset:36864
    ds_read_b64_tr_b16 v[90:91], v1 offset:37376
    v_mfma_f32_32x32x16_bf16 v[32:47], v[76:79], v[204:207], v[32:47]
    ds_read_b64_tr_b16 v[92:93], v2 offset:36864
    ds_read_b64_tr_b16 v[94:95], v2 offset:37376
    s_cmp_gt_u32 s61, 35
    s_cselect_b32 s40, s48, s32
    buffer_load_dwordx4 v[236:239], v8, s[20:23], s40 offen offset:3072
    s_waitcnt vmcnt(7) lgkmcnt(4)
    v_mfma_f32_32x32x16_bf16 v[16:31], v[80:83], v[208:211], v[16:31]
    ds_read_b64_tr_b16 v[96:97], v1 offset:40960
    ds_read_b64_tr_b16 v[98:99], v1 offset:41472
    v_mfma_f32_32x32x16_bf16 v[32:47], v[84:87], v[208:211], v[32:47]
    ds_read_b64_tr_b16 v[100:101], v2 offset:40960
    ds_read_b64_tr_b16 v[102:103], v2 offset:41472
    s_add_u32 s48, s48, 4096
    s_add_u32 s32, s32, 4096
    s_cmp_gt_u32 s61, 36
    s_cselect_b32 s40, s48, s32
    buffer_load_dwordx4 v[192:195], v8, s[20:23], s40 offen
    s_waitcnt vmcnt(7) lgkmcnt(4)
    v_mfma_f32_32x32x16_bf16 v[16:31], v[88:91], v[212:215], v[16:31]
    ds_read_b64_tr_b16 v[72:73], v1 offset:45056
    ds_read_b64_tr_b16 v[74:75], v1 offset:45568
    v_mfma_f32_32x32x16_bf16 v[32:47], v[92:95], v[212:215], v[32:47]
    ds_read_b64_tr_b16 v[76:77], v2 offset:45056
    ds_read_b64_tr_b16 v[78:79], v2 offset:45568
    s_cmp_gt_u32 s61, 37
    s_cselect_b32 s40, s48, s32
    buffer_load_dwordx4 v[196:199], v8, s[20:23], s40 offen offset:1024
    s_waitcnt vmcnt(7) lgkmcnt(4)
    v_mfma_f32_32x32x16_bf16 v[16:31], v[96:99], v[216:219], v[16:31]
    ds_read_b64_tr_b16 v[80:81], v3 offset:32768
    ds_read_b64_tr_b16 v[82:83], v3 offset:33280
    v_mfma_f32_32x32x16_bf16 v[32:47], v[100:103], v[216:219], v[32:47]
    ds_read_b64_tr_b16 v[84:85], v4 offset:32768
    ds_read_b64_tr_b16 v[86:87], v4 offset:33280
    s_cmp_gt_u32 s61, 38
    s_cselect_b32 s40, s48, s32
    buffer_load_dwordx4 v[200:203], v8, s[20:23], s40 offen offset:2048
    s_waitcnt vmcnt(7) lgkmcnt(4)
    v_mfma_f32_32x32x16_bf16 v[16:31], v[72:75], v[220:223], v[16:31]
    ds_read_b64_tr_b16 v[88:89], v3 offset:36864
    ds_read_b64_tr_b16 v[90:91], v3 offset:37376
    v_mfma_f32_32x32x16_bf16 v[32:47], v[76:79], v[220:223], v[32:47]
    ds_read_b64_tr_b16 v[92:93], v4 offset:36864
    ds_read_b64_tr_b16 v[94:95], v4 offset:37376
    s_cmp_gt_u32 s61, 39
    s_cselect_b32 s40, s48, s32
    buffer_load_dwordx4 v[204:207], v8, s[20:23], s40 offen offset:3072
    s_waitcnt vmcnt(7) lgkmcnt(4)
    v_mfma_f32_32x32x16_bf16 v[16:31], v[80:83], v[224:227], v[16:31]
    ds_read_b64_tr_b16 v[96:97], v3 offset:40960
    ds_read_b64_tr_b16 v[98:99], v3 offset:41472
    v_mfma_f32_32x32x16_bf16 v[32:47], v[84:87], v[224:227], v[32:47]
    ds_read_b64_tr_b16 v[100:101], v4 offset:40960
    ds_read_b64_tr_b16 v[102:103], v4 offset:41472
    s_add_u32 s48, s48, 4096
    s_add_u32 s32, s32, 4096
    s_cmp_gt_u32 s61, 40
    s_cselect_b32 s40, s48, s32
    buffer_load_dwordx4 v[208:211], v8, s[20:23], s40 offen
    s_waitcnt vmcnt(7) lgkmcnt(4)
    v_mfma_f32_32x32x16_bf16 v[16:31], v[88:91], v[228:231], v[16:31]
    ds_read_b64_tr_b16 v[72:73], v3 offset:45056
    ds_read_b64_tr_b16 v[74:75], v3 offset:45568
    v_mfma_f32_32x32x16_bf16 v[32:47], v[92:95], v[228:231], v[32:47]
    ds_read_b64_tr_b16 v[76:77], v4 offset:45056
    ds_read_b64_tr_b16 v[78:79], v4 offset:45568
    s_cmp_gt_u32 s61, 41
    s_cselect_b32 s40, s48, s32
    buffer_load_dwordx4 v[212:215], v8, s[20:23], s40 offen offset:1024
    s_waitcnt vmcnt(7) lgkmcnt(4)
    v_mfma_f32_32x32x16_bf16 v[16:31], v[96:99], v[232:235], v[16:31]
    ds_read_b64_tr_b16 v[80:81], v3 offset:49152
    ds_read_b64_tr_b16 v[82:83], v3 offset:49664
    v_mfma_f32_32x32x16_bf16 v[32:47], v[100:103], v[232:235], v[32:47]
    ds_read_b64_tr_b16 v[84:85], v4 offset:49152
    ds_read_b64_tr_b16 v[86:87], v4 offset:49664
    s_cmp_gt_u32 s61, 42
    s_cselect_b32 s40, s48, s32
    buffer_load_dwordx4 v[216:219], v8, s[20:23], s40 offen offset:2048
    buffer_load_dwordx4 v[64:67], v9, s[8:11], 0 offen
    buffer_load_dwordx4 v[68:71], v9, s[8:11], 0 offen offset:16
    s_waitcnt vmcnt(9) lgkmcnt(4)
    v_mfma_f32_32x32x16_bf16 v[16:31], v[72:75], v[236:239], v[16:31]
    ds_read_b64_tr_b16 v[88:89], v3 offset:53248
    ds_read_b64_tr_b16 v[90:91], v3 offset:53760
    v_mfma_f32_32x32x16_bf16 v[32:47], v[76:79], v[236:239], v[32:47]
    ds_read_b64_tr_b16 v[92:93], v4 offset:53248
    ds_read_b64_tr_b16 v[94:95], v4 offset:53760
    s_waitcnt vmcnt(8) lgkmcnt(4)
    v_mfma_f32_32x32x16_bf16 v[16:31], v[80:83], v[192:195], v[16:31]
    ds_read_b64_tr_b16 v[96:97], v1 offset:0
    ds_read_b64_tr_b16 v[98:99], v1 offset:512
    v_mfma_f32_32x32x16_bf16 v[32:47], v[84:87], v[192:195], v[32:47]
    ds_read_b64_tr_b16 v[100:101], v2 offset:0
    ds_read_b64_tr_b16 v[102:103], v2 offset:512
    s_waitcnt vmcnt(7) lgkmcnt(4)
    v_mfma_f32_32x32x16_bf16 v[16:31], v[88:91], v[196:199], v[16:31]
    ds_read_b64_tr_b16 v[72:73], v1 offset:4096
    ds_read_b64_tr_b16 v[74:75], v1 offset:4608
    v_mfma_f32_32x32x16_bf16 v[32:47], v[92:95], v[196:199], v[32:47]
    ds_read_b64_tr_b16 v[76:77], v2 offset:4096
    ds_read_b64_tr_b16 v[78:79], v2 offset:4608
    s_waitcnt vmcnt(6) lgkmcnt(4)
    v_mfma_f32_32x32x16_bf16 v[16:31], v[96:99], v[200:203], v[16:31]
    ds_read_b64_tr_b16 v[80:81], v1 offset:8192
    ds_read_b64_tr_b16 v[82:83], v1 offset:8704
    v_mfma_f32_32x32x16_bf16 v[32:47], v[100:103], v[200:203], v[32:47]
    ds_read_b64_tr_b16 v[84:85], v2 offset:8192
    ds_read_b64_tr_b16 v[86:87], v2 offset:8704
    s_waitcnt vmcnt(5) lgkmcnt(4)
    v_mfma_f32_32x32x16_bf16 v[16:31], v[72:75], v[204:207], v[16:31]
    ds_read_b64_tr_b16 v[88:89], v1 offset:12288
    ds_read_b64_tr_b16 v[90:91], v1 offset:12800
    v_mfma_f32_32x32x16_bf16 v[32:47], v[76:79], v[204:207], v[32:47]
    ds_read_b64_tr_b16 v[92:93], v2 offset:12288
    ds_read_b64_tr_b16 v[94:95], v2 offset:12800
    s_waitcnt vmcnt(4) lgkmcnt(4)
    v_mfma_f32_32x32x16_bf16 v[16:31], v[80:83], v[208:211], v[16:31]
    ds_read_b64_tr_b16 v[96:97], v1 offset:49152
    ds_read_b64_tr_b16 v[98:99], v1 offset:49664
    v_mfma_f32_32x32x16_bf16 v[32:47], v[84:87], v[208:211], v[32:47]
    ds_read_b64_tr_b16 v[100:101], v2 offset:49152
    ds_read_b64_tr_b16 v[102:103], v2 offset:49664
    s_waitcnt vmcnt(3) lgkmcnt(4)
    v_mfma_f32_32x32x16_bf16 v[16:31], v[88:91], v[212:215], v[16:31]
    v_mfma_f32_32x32x16_bf16 v[32:47], v[92:95], v[212:215], v[32:47]
    s_waitcnt vmcnt(2) lgkmcnt(0)
    v_mfma_f32_32x32x16_bf16 v[16:31], v[96:99], v[216:219], v[16:31]
    v_mfma_f32_32x32x16_bf16 v[32:47], v[100:103], v[216:219], v[32:47]
    s_lshl_b32 s44, s53, 1
    s_add_u32 s44, s44, s54
    s_lshl_b32 s44, s44, 12
    s_xor_b32 s45, s44, 4096
    s_add_u32 s45, s45, 139264
    v_add_u32 v10, s45, v8
    s_add_u32 s45, s44, 139264
    v_add_u32 v11, s45, v8
    s_add_u32 s45, s44, 122880
    v_add_u32 v12, s45, v8
    s_nop 3
    ds_write_b128 v10, v[32:35] offset:0
    ds_write_b128 v10, v[36:39] offset:1024
    ds_write_b128 v10, v[40:43] offset:2048
    ds_write_b128 v10, v[44:47] offset:3072
    s_waitcnt lgkmcnt(0)
    s_barrier
    ds_read_b128 v[72:75], v11 offset:0
    ds_read_b128 v[76:79], v11 offset:1024
    ds_read_b128 v[80:83], v11 offset:2048
    ds_read_b128 v[84:87], v11 offset:3072
    ds_read_b128 v[88:91], v12 offset:0
    ds_read_b128 v[92:95], v12 offset:1024
    ds_read_b128 v[96:99], v12 offset:2048
    ds_read_b128 v[100:103], v12 offset:3072
    s_waitcnt lgkmcnt(7)
    v_add_f32 v16, v16, v72
    v_add_f32 v17, v17, v73
    v_add_f32 v18, v18, v74
    v_add_f32 v19, v19, v75
    v_mul_f32 v72, 0xbfb8aa3b, v16
    v_mul_f32 v73, 0xbfb8aa3b, v17
    v_mul_f32 v74, 0xbfb8aa3b, v18
    v_mul_f32 v75, 0xbfb8aa3b, v19
    v_exp_f32 v72, v72
    v_exp_f32 v73, v73
    v_exp_f32 v74, v74
    v_exp_f32 v75, v75
    s_waitcnt lgkmcnt(6)
    v_add_f32 v20, v20, v76
    v_add_f32 v21, v21, v77
    v_add_f32 v22, v22, v78
    v_add_f32 v23, v23, v79
    v_mul_f32 v76, 0xbfb8aa3b, v20
    v_mul_f32 v77, 0xbfb8aa3b, v21
    v_mul_f32 v78, 0xbfb8aa3b, v22
    v_mul_f32 v79, 0xbfb8aa3b, v23
    v_exp_f32 v76, v76
    v_exp_f32 v77, v77
    v_exp_f32 v78, v78
    v_exp_f32 v79, v79
    s_waitcnt lgkmcnt(5)
    v_add_f32 v24, v24, v80
    v_add_f32 v25, v25, v81
    v_add_f32 v26, v26, v82
    v_add_f32 v27, v27, v83
    v_mul_f32 v80, 0xbfb8aa3b, v24
    v_mul_f32 v81, 0xbfb8aa3b, v25
    v_mul_f32 v82, 0xbfb8aa3b, v26
    v_mul_f32 v83, 0xbfb8aa3b, v27
    v_exp_f32 v80, v80
    v_exp_f32 v81, v81
    v_exp_f32 v82, v82
    v_exp_f32 v83, v83
    s_waitcnt lgkmcnt(4)
    v_add_f32 v28, v28, v84
    v_add_f32 v29, v29, v85
    v_add_f32 v30, v30, v86
    v_add_f32 v31, v31, v87
    v_mul_f32 v84, 0xbfb8aa3b, v28
    v_mul_f32 v85, 0xbfb8aa3b, v29
    v_mul_f32 v86, 0xbfb8aa3b, v30
    v_mul_f32 v87, 0xbfb8aa3b, v31
    v_exp_f32 v84, v84
    v_exp_f32 v85, v85
    v_exp_f32 v86, v86
    v_exp_f32 v87, v87
    v_add_f32 v72, 1.0, v72
    v_add_f32 v73, 1.0, v73
    v_add_f32 v74, 1.0, v74
    v_add_f32 v75, 1.0, v75
    v_add_f32 v76, 1.0, v76
    v_add_f32 v77, 1.0, v77
    v_add_f32 v78, 1.0, v78
    v_add_f32 v79, 1.0, v79
    v_add_f32 v80, 1.0, v80
    v_add_f32 v81, 1.0, v81
    v_add_f32 v82, 1.0, v82
    v_add_f32 v83, 1.0, v83
    v_add_f32 v84, 1.0, v84
    v_add_f32 v85, 1.0, v85
    v_add_f32 v86, 1.0, v86
    v_add_f32 v87, 1.0, v87
    v_rcp_f32 v72, v72
    v_rcp_f32 v73, v73
    v_rcp_f32 v74, v74
    v_rcp_f32 v75, v75
    v_rcp_f32 v76, v76
    v_rcp_f32 v77, v77
    v_rcp_f32 v78, v78
    v_rcp_f32 v79, v79
    v_rcp_f32 v80, v80
    v_rcp_f32 v81, v81
    v_rcp_f32 v82, v82
    v_rcp_f32 v83, v83
    v_rcp_f32 v84, v84
    v_rcp_f32 v85, v85
    v_rcp_f32 v86, v86
    v_rcp_f32 v87, v87
    s_waitcnt vmcnt(0) lgkmcnt(0)
    v_lshlrev_b32 v104, 16, v64
    v_and_b32 v105, 0xffff0000, v64
    v_lshlrev_b32 v106, 16, v65
    v_and_b32 v107, 0xffff0000, v65
    v_lshlrev_b32 v108, 16, v66
    v_and_b32 v109, 0xffff0000, v66
    v_lshlrev_b32 v110, 16, v67
    v_and_b32 v111, 0xffff0000, v67
    v_lshlrev_b32 v112, 16, v68
    v_and_b32 v113, 0xffff0000, v68
    v_lshlrev_b32 v114, 16, v69
    v_and_b32 v115, 0xffff0000, v69
    v_lshlrev_b32 v116, 16, v70
    v_and_b32 v117, 0xffff0000, v70
    v_lshlrev_b32 v118, 16, v71
    v_and_b32 v119, 0xffff0000, v71
    v_mul_f32 v16, v16, v72
    v_mul_f32 v17, v17, v73
    v_mul_f32 v18, v18, v74
    v_mul_f32 v19, v19, v75
    v_mul_f32 v20, v20, v76
    v_mul_f32 v21, v21, v77
    v_mul_f32 v22, v22, v78
    v_mul_f32 v23, v23, v79
    v_fmac_f32 v104, v16, v88
    v_fmac_f32 v105, v17, v89
    v_fmac_f32 v106, v18, v90
    v_fmac_f32 v107, v19, v91
    v_fmac_f32 v108, v20, v92
    v_fmac_f32 v109, v21, v93
    v_fmac_f32 v110, v22, v94
    v_fmac_f32 v111, v23, v95
    v_cvt_pk_bf16_f32 v48, v104, v105
    v_cvt_pk_bf16_f32 v49, v106, v107
    v_cvt_pk_bf16_f32 v50, v108, v109
    v_cvt_pk_bf16_f32 v51, v110, v111
    buffer_store_dwordx4 v[48:51], v9, s[24:27], 0 offen
    v_mul_f32 v24, v24, v80
    v_mul_f32 v25, v25, v81
    v_mul_f32 v26, v26, v82
    v_mul_f32 v27, v27, v83
    v_mul_f32 v28, v28, v84
    v_mul_f32 v29, v29, v85
    v_mul_f32 v30, v30, v86
    v_mul_f32 v31, v31, v87
    v_fmac_f32 v112, v24, v96
    v_fmac_f32 v113, v25, v97
    v_fmac_f32 v114, v26, v98
    v_fmac_f32 v115, v27, v99
    v_fmac_f32 v116, v28, v100
    v_fmac_f32 v117, v29, v101
    v_fmac_f32 v118, v30, v102
    v_fmac_f32 v119, v31, v103
    v_cvt_pk_bf16_f32 v52, v112, v113
    v_cvt_pk_bf16_f32 v53, v114, v115
    v_cvt_pk_bf16_f32 v54, v116, v117
    v_cvt_pk_bf16_f32 v55, v118, v119
    buffer_store_dwordx4 v[52:55], v9, s[24:27], 0 offen offset:16
    s_endpgm
L_end:
    s_endpgm
.section .rodata,"a"
.p2align 6
.amdhsa_kernel recurrent_scan__spectral_fnet__glu_gated_bilinear__prompt_kernel
  .amdhsa_next_free_vgpr 256
  .amdhsa_next_free_sgpr 64
  .amdhsa_accum_offset 256
  .amdhsa_group_segment_fixed_size 0
  .amdhsa_kernarg_size 96
  .amdhsa_user_sgpr_count 2
  .amdhsa_user_sgpr_kernarg_segment_ptr 1
  .amdhsa_system_sgpr_workgroup_id_x 1
.end_amdhsa_kernel
```
